```python
import torch

def _softmax(x, axis=-1):
    return torch.softmax(x, dim=axis)
def _gelu(x):
    return torch.nn.functional.gelu(x, approximate="tanh")
def _silu(x):
    return torch.nn.functional.silu(x)
def _sigmoid(x):
    return torch.sigmoid(x)
def _layernorm(x, axis=-1, eps=1e-5):
    m = x.mean(dim=axis, keepdim=True)
    v = x.var(dim=axis, keepdim=True, unbiased=False)
    return (x - m) / torch.sqrt(v + eps)
def _scatter_add(tgt, idx, src, axis=0):
    return tgt.clone().index_add_(axis, idx, src)
def _segment_sum(src, seg, n):
    out = torch.zeros((n,) + src.shape[1:], dtype=src.dtype)
    return out.index_add_(0, seg, src)
def _pad(x, pw):
    flat = tuple(v for pair in reversed(pw) for v in pair)
    return torch.nn.functional.pad(x, flat)

kernel_name = 'standalone__mixer_token_mlp__prompt'

def setup_inputs():

    _w = (lambda a: (lambda t: t.to(torch.bfloat16) if t.is_floating_point() else t)(torch.as_tensor(a)))
    B, S, D, F = 1, 2048, 512, 1376
    return {
        "x": _w((lambda *s: torch.randn(*s, dtype=torch.bfloat16) * 0.05)(B, S, D)),
        "w1": _w((lambda *s: torch.randn(*s, dtype=torch.bfloat16) * 0.2)(S, F) * (S ** -0.5)),
        "b1": _w((lambda *s: torch.randn(*s, dtype=torch.bfloat16) * 1.6)(F) * 0.02),
        "w2": _w((lambda *s: torch.randn(*s, dtype=torch.bfloat16) * 0.05)(F, S) * (F ** -0.5)),
        "b2": _w((lambda *s: torch.randn(*s, dtype=torch.bfloat16) * 0.1)(S) * 0.02),
    }

def reference(x, w1, b1, w2, b2):
    B, S, D = x.shape
    h = _layernorm(x, axis=-1)
    u = torch.einsum("bsd,sf->bdf", h, w1) + b1
    u = _gelu(u)
    y = torch.einsum("bdf,fs->bds", u, w2) + b2
    return (lambda x, *d: x.permute(*d))(y, 0, 2, 1)
```

```asm
; @launch grid=(256,1,1) block=(512,1,1) lds=163840
.amdgcn_target "amdgcn-amd-amdhsa--gfx950"
.text
.globl standalone__mixer_token_mlp__prompt_kernel
.p2align 8
.type standalone__mixer_token_mlp__prompt_kernel,@function
standalone__mixer_token_mlp__prompt_kernel:
    s_load_dwordx16 s[4:19], s[0:1], 0
    s_cmp_ge_u32 s2, 8
    s_cbranch_scc1 L_cpf_done
    s_getpc_b64 s[52:53]
L_pc:
    v_lshlrev_b32 v3, 7, v0
    v_min_u32 v3, L_end-L_pc-4, v3
    global_load_dword v28, v3, s[52:53]
L_cpf_done:

    s_cmp_ge_u32 s2, 256
    s_cbranch_scc1 L_done
    v_lshrrev_b32 v2, 6, v0
    v_and_b32 v1, 63, v0
    v_readfirstlane_b32 s46, v2
    s_and_b32 s44, s2, 7
    s_lshr_b32 s45, s2, 3
    s_and_b32 s41, s2, 1
    s_lshr_b32 s52, s44, 1
    s_mul_i32 s52, s52, 22
    s_add_u32 s52, s52, s45
    s_sub_u32 s52, s52, 10
    s_lshr_b32 s59, s52, 2
    s_and_b32 s55, s52, 3
    s_and_b32 s61, s46, 3
    s_lshr_b32 s49, s61, 1
    s_and_b32 s50, s46, 1
    s_mul_i32 s51, s49, 81920
    s_lshl_b32 s52, s50, 11
    s_add_u32 s51, s51, s52
    s_mov_b32 s23, 0x20000
    s_cmp_ge_u32 s46, 4
    s_cbranch_scc1 L_lw
    s_lshr_b32 s52, s2, 4
    s_lshl_b32 s52, s52, 3
    s_add_u32 s43, s52, s44
    s_lshl_b32 s52, s43, 2
    s_add_u32 s52, s52, s46
    s_lshl_b32 s52, s52, 2
    s_and_b32 s53, s45, 1
    s_sub_u32 s52, s52, s53
    s_add_u32 s52, s52, 1
    s_lshl_b32 s56, s52, 10
    v_lshlrev_b32 v3, 4, v1
    s_mov_b32 s22, 2097152
    s_waitcnt lgkmcnt(0)
    s_mov_b32 s20, s4
    s_mov_b32 s21, s5
    buffer_load_dwordx4 v[8:11], v3, s[20:23], s56 offen
    buffer_load_dwordx4 v[12:15], v3, s[20:23], s56 offen offset:2048
    s_load_dword s40, s[18:19], 61440
    s_branch L_ln

L_lw:
    s_mov_b32 s22, 5636096
    s_cmp_lt_u32 s45, 10
    s_cbranch_scc1 L_agent
    s_mul_i32 s52, s41, 22
    s_cmp_eq_u32 s59, 21
    s_cselect_b32 s52, 0, s52
    s_add_u32 s52, s52, s59
    s_lshl_b32 s47, s52, 7

    v_lshrrev_b32 v4, 3, v1
    v_mul_u32_u24 v3, 5504, v4
    v_bfe_u32 v7, v1, 4, 1
    v_lshlrev_b32 v7, 2, v7
    v_and_b32 v4, 7, v1
    v_xor_b32 v4, v4, v7
    v_lshl_add_u32 v3, v4, 4, v3
    s_mul_i32 s53, s61, 88064
    s_add_u32 s53, s53, s47
    v_add_u32 v8, s53, v3
    v_add_u32 v9, 43008, v8

    s_add_u32 s52, s55, 0
    s_and_b32 s52, s52, 3
    s_mul_i32 s24, s52, 352256
    s_lshl_b32 s52, s52, 12
    s_add_u32 s32, s52, s51

    s_waitcnt lgkmcnt(0)
    s_mov_b32 s20, s6
    s_mov_b32 s21, s7
    s_load_dword s40, s[18:19], 61440
    s_add_u32 m0, s32, 0
    s_add_u32 s56, s24, 0
    buffer_load_dwordx4 v8, s[20:23], s56 offen lds
    buffer_load_dwordx4 v9, s[20:23], s56 offen offset:1024 lds
    s_add_u32 m0, s32, 16384
    s_add_u32 s56, s24, 1409024
    buffer_load_dwordx4 v8, s[20:23], s56 offen lds
    buffer_load_dwordx4 v9, s[20:23], s56 offen offset:1024 lds
    s_add_u32 m0, s32, 32768
    s_add_u32 s56, s24, 2818048
    buffer_load_dwordx4 v8, s[20:23], s56 offen lds
    buffer_load_dwordx4 v9, s[20:23], s56 offen offset:1024 lds
    s_add_u32 m0, s32, 49152
    s_add_u32 s56, s24, 4227072
    buffer_load_dwordx4 v8, s[20:23], s56 offen lds
    buffer_load_dwordx4 v9, s[20:23], s56 offen offset:1024 lds
    s_waitcnt lgkmcnt(0)
    s_mul_i32 s40, s40, 1664525
    s_add_u32 s40, s40, 1013904223
    s_barrier
    s_add_u32 s52, s55, 1
    s_and_b32 s52, s52, 3
    s_mul_i32 s25, s52, 352256
    s_lshl_b32 s52, s52, 12
    s_add_u32 s33, s52, s51

    s_add_u32 s52, s55, 2
    s_and_b32 s52, s52, 3
    s_mul_i32 s26, s52, 352256
    s_lshl_b32 s52, s52, 12
    s_add_u32 s34, s52, s51

    s_add_u32 s52, s55, 3
    s_and_b32 s52, s52, 3
    s_mul_i32 s27, s52, 352256
    s_lshl_b32 s52, s52, 12
    s_add_u32 s35, s52, s51

    s_mov_b32 s36, s18
    s_mov_b32 s37, s19
    s_mov_b32 s38, 65536
    s_mov_b32 s39, 0x20000
    s_xor_b32 s52, s41, 1
    s_lshl_b32 s52, s52, 2
    s_add_u32 s52, s52, s61
    s_lshl_b32 s52, s52, 12
    v_and_b32 v23, 31, v1
    v_lshlrev_b32 v23, 7, v23
    v_add_u32 v23, s52, v23

    s_branch L_l2
L_agent:
    v_mul_u32_u24 v3, 5504, v1
    s_waitcnt lgkmcnt(0)
    s_mov_b32 s20, s6
    s_mov_b32 s21, s7
    s_load_dword s40, s[18:19], 61440
    s_sub_u32 s54, s45, 1
    s_cmp_ge_u32 s54, 8
    s_cbranch_scc1 L_noghost
    s_cmp_lg_u32 s61, 3
    s_cbranch_scc1 L_noghost
    s_lshr_b32 s52, s44, 2
    s_mul_i32 s52, s52, 11
    s_mul_i32 s53, s41, 22
    s_add_u32 s52, s52, s53
    s_add_u32 s52, s52, 5
    s_lshl_b32 s47, s52, 7
    s_bfe_u32 s52, s44, 0x10001
    s_xor_b32 s52, s52, 1
    s_lshl_b32 s52, s52, 1
    s_lshr_b32 s53, s54, 2
    s_add_u32 s52, s52, s53
    s_and_b32 s53, s54, 3
    s_lshl_b32 s53, s53, 2
    s_add_u32 s53, s53, s52
    s_mul_i32 s56, s53, 352256
    s_add_u32 s56, s56, s47
    buffer_load_dword v24, v3, s[20:23], s56 offen
L_noghost:
    s_waitcnt lgkmcnt(0)
    s_mul_i32 s40, s40, 1664525
    s_add_u32 s40, s40, 1013904223
    s_barrier
    s_branch L_agent2

L_ln:
    s_lshl_b32 s42, s59, 1
    s_add_u32 s42, s42, s41
    s_add_u32 s42, s42, s49
    s_cmp_eq_u32 s42, 44
    s_cselect_b32 s42, 0, s42
    s_min_u32 s42, s42, 43

    s_mov_b32 s20, s8
    s_mov_b32 s21, s9
    s_mov_b32 s22, 2752
    s_mov_b32 s23, 0x20000
    s_lshl_b32 s52, s42, 6
    v_lshrrev_b32 v16, 5, v1
    v_lshlrev_b32 v16, 3, v16

    buffer_load_dwordx2 v[128:129], v16, s[20:23], s52 offen offset:0
    buffer_load_dwordx2 v[130:131], v16, s[20:23], s52 offen offset:16
    buffer_load_dwordx2 v[132:133], v16, s[20:23], s52 offen offset:32
    buffer_load_dwordx2 v[134:135], v16, s[20:23], s52 offen offset:48
    s_mov_b32 s28, s12
    s_mov_b32 s29, s13
    s_mov_b32 s30, 4096
    s_mov_b32 s31, 0x20000
    s_and_b32 s53, s45, 7
    s_lshr_b32 s52, s44, 1
    s_lshl_b32 s52, s52, 3
    s_add_u32 s52, s52, s53
    s_lshl_b32 s52, s52, 1
    s_add_u32 s52, s52, s49
    s_lshl_b32 s52, s52, 6
    v_and_b32 v16, 31, v1
    v_lshlrev_b32 v16, 1, v16
    buffer_load_ushort v93, v16, s[28:31], s52 offen

    s_add_u32 s32, s18, 2097152
    s_addc_u32 s33, s19, 0
    s_mov_b32 s34, 2097152
    s_mov_b32 s35, 0x20000
    s_mov_b32 s36, s18
    s_mov_b32 s37, s19
    s_mov_b32 s38, 65536
    s_mov_b32 s39, 0x20000
    v_lshlrev_b32 v3, 4, v1
    v_and_b32 v46, 7, v1
    v_and_b32 v44, 31, v1
    v_lshlrev_b32 v44, 7, v44
    v_lshl_add_u32 v44, v46, 4, v44
    v_lshrrev_b32 v47, 5, v1
    v_mul_u32_u24 v47, 81920, v47
    s_lshl_b32 s53, s46, 2
    s_add_u32 s53, s53, 65536
    v_add3_u32 v44, v44, v47, s53
    v_lshrrev_b32 v47, 3, v1
    v_xor_b32 v46, v46, v47
    v_lshlrev_b32 v45, 7, v47
    v_lshl_add_u32 v45, v46, 4, v45
    s_add_u32 s52, s51, 65536
    v_add_u32 v45, s52, v45
    s_and_b32 s52, s45, 1
    s_lshl_b32 s52, s52, 7
    s_add_u32 s43, s43, s52
    s_lshl_b32 s57, s43, 13
    s_lshl_b32 s52, s46, 11
    s_add_u32 s57, s57, s52
    v_mov_b32 v48, 0x3727c5ac
    v_mov_b32 v49, 0x3b000000
    v_mov_b32 v50, 69632
    v_mov_b32 v51, 0
    ds_write_b32 v50, v51
    v_mov_b32 v51, 1
    s_lshl_b32 s52, s43, 7
    v_mov_b32 v23, s52

    s_waitcnt vmcnt(6)
    v_lshlrev_b32 v24, 16, v8
    v_and_b32 v25, 0xffff0000, v8
    v_lshlrev_b32 v26, 16, v9
    v_and_b32 v27, 0xffff0000, v9
    v_lshlrev_b32 v28, 16, v10
    v_and_b32 v29, 0xffff0000, v10
    v_lshlrev_b32 v30, 16, v11
    v_and_b32 v31, 0xffff0000, v11
    v_pk_add_f32 v[40:41], v[24:25], v[26:27]
    v_pk_add_f32 v[52:53], v[28:29], v[30:31]
    v_pk_add_f32 v[40:41], v[40:41], v[52:53]
    v_add_f32 v40, v40, v41
    s_waitcnt vmcnt(5)
    v_lshlrev_b32 v32, 16, v12
    v_and_b32 v33, 0xffff0000, v12
    v_lshlrev_b32 v34, 16, v13
    v_and_b32 v35, 0xffff0000, v13
    v_lshlrev_b32 v36, 16, v14
    v_and_b32 v37, 0xffff0000, v14
    v_lshlrev_b32 v38, 16, v15
    v_and_b32 v39, 0xffff0000, v15
    v_pk_add_f32 v[42:43], v[32:33], v[34:35]
    v_pk_add_f32 v[52:53], v[36:37], v[38:39]
    v_pk_add_f32 v[42:43], v[42:43], v[52:53]
    v_add_f32 v42, v42, v43
    s_nop 1
    v_permlane32_swap_b32 v40, v42
    s_nop 1
    v_add_f32 v40, v40, v42
    v_mov_b32 v42, v40
    s_nop 1
    v_permlane16_swap_b32 v40, v42
    s_nop 1
    v_add_f32 v40, v40, v42
    s_nop 1
    v_add_f32_dpp v40, v40, v40 row_ror:8 row_mask:0xf bank_mask:0xf
    s_nop 1
    v_add_f32_dpp v40, v40, v40 row_ror:4 row_mask:0xf bank_mask:0xf
    s_nop 1
    v_add_f32_dpp v40, v40, v40 row_ror:2 row_mask:0xf bank_mask:0xf
    s_nop 1
    v_add_f32_dpp v40, v40, v40 row_ror:1 row_mask:0xf bank_mask:0xf
    v_mul_f32 v40, 0xbb000000, v40
    s_nop 1
    v_readlane_b32 s24, v40, 0
    v_readlane_b32 s26, v40, 32
    s_nop 1
    v_pk_add_f32 v[24:25], v[24:25], s[24:25] op_sel_hi:[1,0]
    v_pk_add_f32 v[26:27], v[26:27], s[24:25] op_sel_hi:[1,0]
    v_pk_add_f32 v[28:29], v[28:29], s[24:25] op_sel_hi:[1,0]
    v_pk_add_f32 v[30:31], v[30:31], s[24:25] op_sel_hi:[1,0]
    v_pk_mul_f32 v[40:41], v[24:25], v[24:25]
    v_pk_fma_f32 v[40:41], v[26:27], v[26:27], v[40:41]
    v_pk_fma_f32 v[40:41], v[28:29], v[28:29], v[40:41]
    v_pk_fma_f32 v[40:41], v[30:31], v[30:31], v[40:41]
    v_add_f32 v40, v40, v41
    v_pk_add_f32 v[32:33], v[32:33], s[26:27] op_sel_hi:[1,0]
    v_pk_add_f32 v[34:35], v[34:35], s[26:27] op_sel_hi:[1,0]
    v_pk_add_f32 v[36:37], v[36:37], s[26:27] op_sel_hi:[1,0]
    v_pk_add_f32 v[38:39], v[38:39], s[26:27] op_sel_hi:[1,0]
    v_pk_mul_f32 v[42:43], v[32:33], v[32:33]
    v_pk_fma_f32 v[42:43], v[34:35], v[34:35], v[42:43]
    v_pk_fma_f32 v[42:43], v[36:37], v[36:37], v[42:43]
    v_pk_fma_f32 v[42:43], v[38:39], v[38:39], v[42:43]
    v_add_f32 v42, v42, v43
    s_nop 1
    v_permlane32_swap_b32 v40, v42
    s_nop 1
    v_add_f32 v40, v40, v42
    v_mov_b32 v42, v40
    s_nop 1
    v_permlane16_swap_b32 v40, v42
    s_nop 1
    v_add_f32 v40, v40, v42
    s_nop 1
    v_add_f32_dpp v40, v40, v40 row_ror:8 row_mask:0xf bank_mask:0xf
    s_nop 1
    v_add_f32_dpp v40, v40, v40 row_ror:4 row_mask:0xf bank_mask:0xf
    s_nop 1
    v_add_f32_dpp v40, v40, v40 row_ror:2 row_mask:0xf bank_mask:0xf
    s_nop 1
    v_add_f32_dpp v40, v40, v40 row_ror:1 row_mask:0xf bank_mask:0xf
    v_fma_f32 v40, v40, v49, v48
    v_rsq_f32 v40, v40
    s_nop 1
    v_readlane_b32 s24, v40, 0
    v_readlane_b32 s26, v40, 32
    s_nop 1
    v_pk_mul_f32 v[24:25], v[24:25], s[24:25] op_sel_hi:[1,0]
    v_pk_mul_f32 v[26:27], v[26:27], s[24:25] op_sel_hi:[1,0]
    v_pk_mul_f32 v[28:29], v[28:29], s[24:25] op_sel_hi:[1,0]
    v_pk_mul_f32 v[30:31], v[30:31], s[24:25] op_sel_hi:[1,0]
    v_pk_mul_f32 v[32:33], v[32:33], s[26:27] op_sel_hi:[1,0]
    v_pk_mul_f32 v[34:35], v[34:35], s[26:27] op_sel_hi:[1,0]
    v_pk_mul_f32 v[36:37], v[36:37], s[26:27] op_sel_hi:[1,0]
    v_pk_mul_f32 v[38:39], v[38:39], s[26:27] op_sel_hi:[1,0]
    v_cvt_pk_bf16_f32 v56, v24, v32
    v_xor_b32 v46, 0, v44
    ds_write_b32 v46, v56
    v_cvt_pk_bf16_f32 v57, v25, v33
    v_xor_b32 v46, 16, v44
    ds_write_b32 v46, v57
    v_cvt_pk_bf16_f32 v58, v26, v34
    v_xor_b32 v46, 32, v44
    ds_write_b32 v46, v58
    v_cvt_pk_bf16_f32 v59, v27, v35
    v_xor_b32 v46, 48, v44
    ds_write_b32 v46, v59
    v_cvt_pk_bf16_f32 v60, v28, v36
    v_xor_b32 v46, 64, v44
    ds_write_b32 v46, v60
    v_cvt_pk_bf16_f32 v61, v29, v37
    v_xor_b32 v46, 80, v44
    ds_write_b32 v46, v61
    v_cvt_pk_bf16_f32 v62, v30, v38
    v_xor_b32 v46, 96, v44
    ds_write_b32 v46, v62
    v_cvt_pk_bf16_f32 v63, v31, v39
    v_xor_b32 v46, 112, v44
    ds_write_b32 v46, v63
    s_waitcnt lgkmcnt(0)
    s_mul_i32 s40, s40, 1664525
    s_add_u32 s40, s40, 1013904223
    s_barrier
    ds_read_b128 v[24:27], v45 offset:0
    ds_read_b128 v[28:31], v45 offset:1024
    s_waitcnt lgkmcnt(1)
    buffer_store_dwordx4 v[24:27], v3, s[32:35], s57 offen offset:0 sc1
    s_waitcnt lgkmcnt(0)
    buffer_store_dwordx4 v[28:31], v3, s[32:35], s57 offen offset:1024 sc1
    v_mov_b32 v2, s40
    v_readfirstlane_b32 s3, v23
    s_mov_b32 s63, s40
    s_mov_b64 exec, 1
    s_waitcnt vmcnt(0)
    ds_add_rtn_u32 v51, v50, v51
    s_waitcnt lgkmcnt(0)
    v_cmp_eq_u32 vcc, 3, v51
    s_cbranch_vccz L_nopub1

    buffer_store_dword v2, v23, s[36:39], 0 offen sc1
L_nopub1:
    s_mov_b64 exec, -1

    s_barrier
    s_cmp_lt_u32 s45, 10
    s_cbranch_scc1 L_hc
    s_lshl_b32 s48, s55, 1
    s_add_u32 s48, s48, s41
    s_lshl_b32 s48, s48, 6

    v_lshrrev_b32 v5, 5, v1
    v_and_b32 v6, 31, v1
    v_lshl_add_u32 v4, v5, 9, v6
    v_add_u32 v4, s48, v4
    v_lshlrev_b32 v4, 4, v4
    s_lshl_b32 s52, s50, 9
    s_lshl_b32 s53, s49, 15
    s_add_u32 s52, s52, s53
    v_add_u32 v12, s52, v4
    v_add_u32 v13, 0x4000, v12

    v_xor_b32 v10, 0x400, v12
    v_xor_b32 v11, 0x400, v13
    v_bfe_u32 v7, v1, 2, 2
    v_lshl_add_u32 v16, v5, 3, v7
    v_lshlrev_b32 v16, 7, v16
    v_and_b32 v17, 3, v1
    v_lshl_add_u32 v16, v17, 3, v16
    v_bfe_u32 v17, v1, 4, 1
    v_lshl_add_u32 v16, v17, 5, v16
    v_bfe_u32 v17, v1, 3, 1
    v_xor_b32 v17, s49, v17
    v_lshl_add_u32 v16, v17, 6, v16
    s_mul_i32 s52, s49, 81920
    v_add_u32 v18, s52, v16
    v_xor_b32 v19, 64, v18
    v_add_u32 v20, 0x10000, v18
    v_add_u32 v21, 0x10000, v19

    s_xor_b32 s52, s41, 1
    s_lshl_b32 s52, s52, 20
    s_add_u32 s52, s52, 2097152
    s_add_u32 s24, s18, s52
    s_addc_u32 s25, s19, 0
    s_mov_b32 s26, 1048576
    s_mov_b32 s27, 0x20000

    s_add_u32 s32, s18, 65536
    s_addc_u32 s33, s19, 0
    s_mov_b32 s34, 1409024
    s_mov_b32 s35, 0x20000
    v_mov_b32 v40, 0
    v_mov_b32 v41, 0
    v_mov_b32 v42, 0
    v_mov_b32 v43, 0
    v_mov_b32 v44, 0
    v_mov_b32 v45, 0
    v_mov_b32 v46, 0
    v_mov_b32 v47, 0
    v_mov_b32 v48, 0
    v_mov_b32 v49, 0
    v_mov_b32 v50, 0
    v_mov_b32 v51, 0
    v_mov_b32 v52, 0
    v_mov_b32 v53, 0
    v_mov_b32 v54, 0
    v_mov_b32 v55, 0
    v_mov_b32 v56, 0
    v_mov_b32 v57, 0
    v_mov_b32 v58, 0
    v_mov_b32 v59, 0
    v_mov_b32 v60, 0
    v_mov_b32 v61, 0
    v_mov_b32 v62, 0
    v_mov_b32 v63, 0
    v_mov_b32 v64, 0
    v_mov_b32 v65, 0
    v_mov_b32 v66, 0
    v_mov_b32 v67, 0
    v_mov_b32 v68, 0
    v_mov_b32 v69, 0
    v_mov_b32 v70, 0
    v_mov_b32 v71, 0
    v_mov_b32 v72, 0
    v_mov_b32 v73, 0
    v_mov_b32 v74, 0
    v_mov_b32 v75, 0
    v_mov_b32 v76, 0
    v_mov_b32 v77, 0
    v_mov_b32 v78, 0
    v_mov_b32 v79, 0
    v_mov_b32 v80, 0
    v_mov_b32 v81, 0
    v_mov_b32 v82, 0
    v_mov_b32 v83, 0
    v_mov_b32 v84, 0
    v_mov_b32 v85, 0
    v_mov_b32 v86, 0
    v_mov_b32 v87, 0
    v_lshlrev_b32 v16, 4, v1
    s_mul_i32 s52, s49, 81920
    s_lshl_b32 s53, s50, 12
    s_add_u32 s53, s53, 73728
    s_add_u32 s52, s52, s53
    v_add_u32 v17, s52, v16
    s_xor_b32 s52, s49, 1
    s_mul_i32 s52, s52, 81920
    s_add_u32 s52, s52, s53
    v_add_u32 v22, s52, v16

    v_subrev_u32 v89, 8192, v17
    v_subrev_u32 v90, 8192, v22
    v_mov_b32 v95, 0xff
    s_mov_b32 s60, 0xbdd2d3e8
    v_mov_b32 v14, 0xc0135761
    v_mov_b32 v15, 0xc0135761
    s_lshl_b32 s52, s42, 11
    s_add_u32 s52, s52, s48
    s_lshl_b32 s53, s50, 5
    s_add_u32 s52, s52, s53
    v_lshl_add_u32 v16, v5, 9, v6
    v_add_u32 v16, s52, v16
    v_lshlrev_b32 v16, 4, v16
    s_lshr_b32 s52, s48, 6
    s_mul_i32 s52, s52, 22
    s_add_u32 s52, s52, s59
    s_lshl_b32 s52, s52, 7
    s_add_u32 s52, s52, 32768
    v_mov_b32 v23, s52
    v_mov_b32 v91, 81920
    v_mov_b32 v92, 1

    s_add_u32 s28, s18, 4194304
    s_addc_u32 s29, s19, 0
    s_mov_b32 s30, 2883584
    s_mov_b32 s31, 0x20000
    s_lshr_b32 s52, s48, 6
    s_mul_i32 s52, s52, 44
    s_add_u32 s52, s52, s42
    s_lshl_b32 s52, s52, 13
    s_lshl_b32 s53, s50, 12
    s_add_u32 s52, s52, s53
    v_lshlrev_b32 v88, 4, v1
    v_add_u32 v88, s52, v88
    s_cmp_eq_u32 s41, 0
    s_mov_b32 s53, 360448
    s_cselect_b32 s52, s53, 4294606848
    v_add_u32 v94, s52, v88
    s_mul_i32 s20, s40, 0x9e3779b1
    s_bfe_u32 s21, s20, 0x80008
    s_bfe_u32 s22, s20, 0x80010
    s_lshr_b32 s23, s20, 24
    s_and_b32 s20, s20, 0xff

    v_lshlrev_b32 v24, 16, v128
    v_and_b32 v25, 0xffff0000, v128
    v_lshlrev_b32 v26, 16, v129
    v_and_b32 v27, 0xffff0000, v129
    v_lshlrev_b32 v28, 16, v130
    v_and_b32 v29, 0xffff0000, v130
    v_lshlrev_b32 v30, 16, v131
    v_and_b32 v31, 0xffff0000, v131
    v_lshlrev_b32 v32, 16, v132
    v_and_b32 v33, 0xffff0000, v132
    v_lshlrev_b32 v34, 16, v133
    v_and_b32 v35, 0xffff0000, v133
    v_lshlrev_b32 v36, 16, v134
    v_and_b32 v37, 0xffff0000, v134
    v_lshlrev_b32 v38, 16, v135
    v_and_b32 v39, 0xffff0000, v135
    s_waitcnt lgkmcnt(0)
    s_barrier
    s_mov_b32 s57, 0
    buffer_load_dwordx4 v[128:131], v10, s[24:27], s57 offen sc1
    buffer_load_dwordx4 v[132:135], v11, s[24:27], s57 offen sc1
    s_mov_b32 s57, 65536
    buffer_load_dwordx4 v[136:139], v10, s[24:27], s57 offen sc1
    buffer_load_dwordx4 v[140:143], v11, s[24:27], s57 offen sc1
    s_mov_b32 s57, 131072
    buffer_load_dwordx4 v[144:147], v10, s[24:27], s57 offen sc1
    buffer_load_dwordx4 v[148:151], v11, s[24:27], s57 offen sc1
    s_mov_b32 s57, 196608
    buffer_load_dwordx4 v[152:155], v10, s[24:27], s57 offen sc1
    buffer_load_dwordx4 v[156:159], v11, s[24:27], s57 offen sc1
    s_mov_b32 s57, 262144
    buffer_load_dwordx4 v[160:163], v10, s[24:27], s57 offen sc1
    buffer_load_dwordx4 v[164:167], v11, s[24:27], s57 offen sc1
    s_mov_b32 s57, 327680
    buffer_load_dwordx4 v[168:171], v10, s[24:27], s57 offen sc1
    buffer_load_dwordx4 v[172:175], v11, s[24:27], s57 offen sc1
    ds_read_b64_tr_b16 v[96:97], v18 offset:0
    ds_read_b64_tr_b16 v[98:99], v18 offset:512
    ds_read_b64_tr_b16 v[100:101], v19 offset:0
    ds_read_b64_tr_b16 v[102:103], v19 offset:512
    ds_read_b64_tr_b16 v[104:105], v18 offset:2048
    ds_read_b64_tr_b16 v[106:107], v18 offset:2560
    ds_read_b64_tr_b16 v[108:109], v19 offset:2048
    ds_read_b64_tr_b16 v[110:111], v19 offset:2560
    s_waitcnt vmcnt(11)
    s_waitcnt lgkmcnt(6)
    v_mfma_f32_32x32x16_bf16 v[56:71], v[96:99], v[128:131], v[56:71]
    ds_read_b64_tr_b16 v[112:113], v18 offset:4096
    ds_read_b64_tr_b16 v[114:115], v18 offset:4608
    s_mov_b32 s57, 393216
    buffer_load_dwordx4 v[176:179], v10, s[24:27], s57 offen sc1
    s_waitcnt lgkmcnt(6)
    v_mfma_f32_32x32x16_bf16 v[72:87], v[100:103], v[128:131], v[72:87]
    ds_read_b64_tr_b16 v[116:117], v19 offset:4096
    ds_read_b64_tr_b16 v[118:119], v19 offset:4608
    buffer_load_dwordx4 v[180:183], v11, s[24:27], s57 offen sc1
    s_waitcnt vmcnt(12)
    s_waitcnt lgkmcnt(6)
    v_mfma_f32_32x32x16_bf16 v[56:71], v[104:107], v[132:135], v[56:71]
    ds_read_b64_tr_b16 v[120:121], v18 offset:6144
    ds_read_b64_tr_b16 v[122:123], v18 offset:6656
    s_waitcnt lgkmcnt(6)
    v_mfma_f32_32x32x16_bf16 v[72:87], v[108:111], v[132:135], v[72:87]
    ds_read_b64_tr_b16 v[124:125], v19 offset:6144
    ds_read_b64_tr_b16 v[126:127], v19 offset:6656
    s_waitcnt vmcnt(11)
    s_waitcnt lgkmcnt(6)
    v_mfma_f32_32x32x16_bf16 v[56:71], v[112:115], v[136:139], v[56:71]
    ds_read_b64_tr_b16 v[96:97], v18 offset:8192
    ds_read_b64_tr_b16 v[98:99], v18 offset:8704
    s_mov_b32 s57, 458752
    buffer_load_dwordx4 v[128:131], v10, s[24:27], s57 offen sc1
    s_waitcnt lgkmcnt(6)
    v_mfma_f32_32x32x16_bf16 v[72:87], v[116:119], v[136:139], v[72:87]
    ds_read_b64_tr_b16 v[100:101], v19 offset:8192
    ds_read_b64_tr_b16 v[102:103], v19 offset:8704
    buffer_load_dwordx4 v[132:135], v11, s[24:27], s57 offen sc1
    s_waitcnt vmcnt(12)
    s_waitcnt lgkmcnt(6)
    v_mfma_f32_32x32x16_bf16 v[56:71], v[120:123], v[140:143], v[56:71]
    ds_read_b64_tr_b16 v[104:105], v18 offset:10240
    ds_read_b64_tr_b16 v[106:107], v18 offset:10752
    s_waitcnt lgkmcnt(6)
    v_mfma_f32_32x32x16_bf16 v[72:87], v[124:127], v[140:143], v[72:87]
    ds_read_b64_tr_b16 v[108:109], v19 offset:10240
    ds_read_b64_tr_b16 v[110:111], v19 offset:10752
    s_waitcnt vmcnt(11)
    s_waitcnt lgkmcnt(6)
    v_mfma_f32_32x32x16_bf16 v[56:71], v[96:99], v[144:147], v[56:71]
    ds_read_b64_tr_b16 v[112:113], v18 offset:12288
    ds_read_b64_tr_b16 v[114:115], v18 offset:12800
    s_mov_b32 s57, 524288
    buffer_load_dwordx4 v[136:139], v10, s[24:27], s57 offen sc1
    s_waitcnt lgkmcnt(6)
    v_mfma_f32_32x32x16_bf16 v[72:87], v[100:103], v[144:147], v[72:87]
    ds_read_b64_tr_b16 v[116:117], v19 offset:12288
    ds_read_b64_tr_b16 v[118:119], v19 offset:12800
    buffer_load_dwordx4 v[140:143], v11, s[24:27], s57 offen sc1
    s_waitcnt vmcnt(12)
    s_waitcnt lgkmcnt(6)
    v_mfma_f32_32x32x16_bf16 v[56:71], v[104:107], v[148:151], v[56:71]
    ds_read_b64_tr_b16 v[120:121], v18 offset:14336
    ds_read_b64_tr_b16 v[122:123], v18 offset:14848
    s_waitcnt lgkmcnt(6)
    v_mfma_f32_32x32x16_bf16 v[72:87], v[108:111], v[148:151], v[72:87]
    ds_read_b64_tr_b16 v[124:125], v19 offset:14336
    ds_read_b64_tr_b16 v[126:127], v19 offset:14848
    s_waitcnt vmcnt(11)
    s_waitcnt lgkmcnt(6)
    v_mfma_f32_32x32x16_bf16 v[56:71], v[112:115], v[152:155], v[56:71]
    ds_read_b64_tr_b16 v[96:97], v18 offset:16384
    ds_read_b64_tr_b16 v[98:99], v18 offset:16896
    s_mov_b32 s57, 589824
    buffer_load_dwordx4 v[144:147], v10, s[24:27], s57 offen sc1
    s_waitcnt lgkmcnt(6)
    v_mfma_f32_32x32x16_bf16 v[72:87], v[116:119], v[152:155], v[72:87]
    ds_read_b64_tr_b16 v[100:101], v19 offset:16384
    ds_read_b64_tr_b16 v[102:103], v19 offset:16896
    buffer_load_dwordx4 v[148:151], v11, s[24:27], s57 offen sc1
    s_waitcnt vmcnt(12)
    s_waitcnt lgkmcnt(6)
    v_mfma_f32_32x32x16_bf16 v[56:71], v[120:123], v[156:159], v[56:71]
    ds_read_b64_tr_b16 v[104:105], v18 offset:18432
    ds_read_b64_tr_b16 v[106:107], v18 offset:18944
    s_waitcnt lgkmcnt(6)
    v_mfma_f32_32x32x16_bf16 v[72:87], v[124:127], v[156:159], v[72:87]
    ds_read_b64_tr_b16 v[108:109], v19 offset:18432
    ds_read_b64_tr_b16 v[110:111], v19 offset:18944
    s_waitcnt vmcnt(11)
    s_waitcnt lgkmcnt(6)
    v_mfma_f32_32x32x16_bf16 v[56:71], v[96:99], v[160:163], v[56:71]
    ds_read_b64_tr_b16 v[112:113], v18 offset:20480
    ds_read_b64_tr_b16 v[114:115], v18 offset:20992
    s_mov_b32 s57, 655360
    buffer_load_dwordx4 v[152:155], v10, s[24:27], s57 offen sc1
    s_waitcnt lgkmcnt(6)
    v_mfma_f32_32x32x16_bf16 v[72:87], v[100:103], v[160:163], v[72:87]
    ds_read_b64_tr_b16 v[116:117], v19 offset:20480
    ds_read_b64_tr_b16 v[118:119], v19 offset:20992
    buffer_load_dwordx4 v[156:159], v11, s[24:27], s57 offen sc1
    s_waitcnt vmcnt(12)
    s_waitcnt lgkmcnt(6)
    v_mfma_f32_32x32x16_bf16 v[56:71], v[104:107], v[164:167], v[56:71]
    ds_read_b64_tr_b16 v[120:121], v18 offset:22528
    ds_read_b64_tr_b16 v[122:123], v18 offset:23040
    s_waitcnt lgkmcnt(6)
    v_mfma_f32_32x32x16_bf16 v[72:87], v[108:111], v[164:167], v[72:87]
    ds_read_b64_tr_b16 v[124:125], v19 offset:22528
    ds_read_b64_tr_b16 v[126:127], v19 offset:23040
    s_waitcnt vmcnt(11)
    s_waitcnt lgkmcnt(6)
    v_mfma_f32_32x32x16_bf16 v[56:71], v[112:115], v[168:171], v[56:71]
    ds_read_b64_tr_b16 v[96:97], v18 offset:24576
    ds_read_b64_tr_b16 v[98:99], v18 offset:25088
    s_mov_b32 s57, 720896
    buffer_load_dwordx4 v[160:163], v10, s[24:27], s57 offen sc1
    s_waitcnt lgkmcnt(6)
    v_mfma_f32_32x32x16_bf16 v[72:87], v[116:119], v[168:171], v[72:87]
    ds_read_b64_tr_b16 v[100:101], v19 offset:24576
    ds_read_b64_tr_b16 v[102:103], v19 offset:25088
    buffer_load_dwordx4 v[164:167], v11, s[24:27], s57 offen sc1
    s_waitcnt vmcnt(12)
    s_waitcnt lgkmcnt(6)
    v_mfma_f32_32x32x16_bf16 v[56:71], v[120:123], v[172:175], v[56:71]
    ds_read_b64_tr_b16 v[104:105], v18 offset:26624
    ds_read_b64_tr_b16 v[106:107], v18 offset:27136
    s_waitcnt lgkmcnt(6)
    v_mfma_f32_32x32x16_bf16 v[72:87], v[124:127], v[172:175], v[72:87]
    ds_read_b64_tr_b16 v[108:109], v19 offset:26624
    ds_read_b64_tr_b16 v[110:111], v19 offset:27136
    s_waitcnt vmcnt(11)
    s_waitcnt lgkmcnt(6)
    v_mfma_f32_32x32x16_bf16 v[56:71], v[96:99], v[176:179], v[56:71]
    ds_read_b64_tr_b16 v[112:113], v18 offset:28672
    ds_read_b64_tr_b16 v[114:115], v18 offset:29184
    s_mov_b32 s57, 786432
    buffer_load_dwordx4 v[168:171], v10, s[24:27], s57 offen sc1
    s_waitcnt lgkmcnt(6)
    v_mfma_f32_32x32x16_bf16 v[72:87], v[100:103], v[176:179], v[72:87]
    ds_read_b64_tr_b16 v[116:117], v19 offset:28672
    ds_read_b64_tr_b16 v[118:119], v19 offset:29184
    buffer_load_dwordx4 v[172:175], v11, s[24:27], s57 offen sc1
    s_waitcnt vmcnt(12)
    s_waitcnt lgkmcnt(6)
    v_mfma_f32_32x32x16_bf16 v[56:71], v[104:107], v[180:183], v[56:71]
    ds_read_b64_tr_b16 v[120:121], v18 offset:30720
    ds_read_b64_tr_b16 v[122:123], v18 offset:31232
    s_waitcnt lgkmcnt(6)
    v_mfma_f32_32x32x16_bf16 v[72:87], v[108:111], v[180:183], v[72:87]
    ds_read_b64_tr_b16 v[124:125], v19 offset:30720
    ds_read_b64_tr_b16 v[126:127], v19 offset:31232
    s_waitcnt vmcnt(11)
    s_waitcnt lgkmcnt(6)
    v_mfma_f32_32x32x16_bf16 v[56:71], v[112:115], v[128:131], v[56:71]
    ds_read_b64_tr_b16 v[96:97], v18 offset:32768
    ds_read_b64_tr_b16 v[98:99], v18 offset:33280
    s_mov_b32 s57, 851968
    buffer_load_dwordx4 v[176:179], v10, s[24:27], s57 offen sc1
    s_waitcnt lgkmcnt(6)
    v_mfma_f32_32x32x16_bf16 v[72:87], v[116:119], v[128:131], v[72:87]
    ds_read_b64_tr_b16 v[100:101], v19 offset:32768
    ds_read_b64_tr_b16 v[102:103], v19 offset:33280
    buffer_load_dwordx4 v[180:183], v11, s[24:27], s57 offen sc1
    s_waitcnt vmcnt(12)
    s_waitcnt lgkmcnt(6)
    v_mfma_f32_32x32x16_bf16 v[56:71], v[120:123], v[132:135], v[56:71]
    ds_read_b64_tr_b16 v[104:105], v18 offset:34816
    ds_read_b64_tr_b16 v[106:107], v18 offset:35328
    s_waitcnt lgkmcnt(6)
    v_mfma_f32_32x32x16_bf16 v[72:87], v[124:127], v[132:135], v[72:87]
    ds_read_b64_tr_b16 v[108:109], v19 offset:34816
    ds_read_b64_tr_b16 v[110:111], v19 offset:35328
    s_waitcnt vmcnt(11)
    s_waitcnt lgkmcnt(6)
    v_mfma_f32_32x32x16_bf16 v[56:71], v[96:99], v[136:139], v[56:71]
    ds_read_b64_tr_b16 v[112:113], v18 offset:36864
    ds_read_b64_tr_b16 v[114:115], v18 offset:37376
    s_mov_b32 s57, 917504
    buffer_load_dwordx4 v[128:131], v10, s[24:27], s57 offen sc1
    s_waitcnt lgkmcnt(6)
    v_mfma_f32_32x32x16_bf16 v[72:87], v[100:103], v[136:139], v[72:87]
    ds_read_b64_tr_b16 v[116:117], v19 offset:36864
    ds_read_b64_tr_b16 v[118:119], v19 offset:37376
    buffer_load_dwordx4 v[132:135], v11, s[24:27], s57 offen sc1
    s_waitcnt vmcnt(12)
    s_waitcnt lgkmcnt(6)
    v_mfma_f32_32x32x16_bf16 v[56:71], v[104:107], v[140:143], v[56:71]
    ds_read_b64_tr_b16 v[120:121], v18 offset:38912
    ds_read_b64_tr_b16 v[122:123], v18 offset:39424
    s_waitcnt lgkmcnt(6)
    v_mfma_f32_32x32x16_bf16 v[72:87], v[108:111], v[140:143], v[72:87]
    ds_read_b64_tr_b16 v[124:125], v19 offset:38912
    ds_read_b64_tr_b16 v[126:127], v19 offset:39424
    s_waitcnt vmcnt(11)
    s_waitcnt lgkmcnt(6)
    v_mfma_f32_32x32x16_bf16 v[56:71], v[112:115], v[144:147], v[56:71]
    ds_read_b64_tr_b16 v[96:97], v18 offset:40960
    ds_read_b64_tr_b16 v[98:99], v18 offset:41472
    s_mov_b32 s57, 983040
    buffer_load_dwordx4 v[136:139], v10, s[24:27], s57 offen sc1
    s_waitcnt lgkmcnt(6)
    v_mfma_f32_32x32x16_bf16 v[72:87], v[116:119], v[144:147], v[72:87]
    ds_read_b64_tr_b16 v[100:101], v19 offset:40960
    ds_read_b64_tr_b16 v[102:103], v19 offset:41472
    buffer_load_dwordx4 v[140:143], v11, s[24:27], s57 offen sc1
    s_waitcnt vmcnt(12)
    s_waitcnt lgkmcnt(6)
    v_mfma_f32_32x32x16_bf16 v[56:71], v[120:123], v[148:151], v[56:71]
    ds_read_b64_tr_b16 v[104:105], v18 offset:43008
    ds_read_b64_tr_b16 v[106:107], v18 offset:43520
    s_waitcnt lgkmcnt(6)
    v_mfma_f32_32x32x16_bf16 v[72:87], v[124:127], v[148:151], v[72:87]
    ds_read_b64_tr_b16 v[108:109], v19 offset:43008
    ds_read_b64_tr_b16 v[110:111], v19 offset:43520
    s_waitcnt vmcnt(11)
    s_waitcnt lgkmcnt(6)
    v_mfma_f32_32x32x16_bf16 v[56:71], v[96:99], v[152:155], v[56:71]
    ds_read_b64_tr_b16 v[112:113], v18 offset:45056
    ds_read_b64_tr_b16 v[114:115], v18 offset:45568
    s_mov_b32 s57, 0
    buffer_load_dwordx4 v[144:147], v12, s[24:27], s57 offen sc1
    s_waitcnt lgkmcnt(6)
    v_mfma_f32_32x32x16_bf16 v[72:87], v[100:103], v[152:155], v[72:87]
    ds_read_b64_tr_b16 v[116:117], v19 offset:45056
    ds_read_b64_tr_b16 v[118:119], v19 offset:45568
    buffer_load_dwordx4 v[148:151], v13, s[24:27], s57 offen sc1
    s_waitcnt vmcnt(12)
    s_waitcnt lgkmcnt(6)
    v_mfma_f32_32x32x16_bf16 v[56:71], v[104:107], v[156:159], v[56:71]
    ds_read_b64_tr_b16 v[120:121], v18 offset:47104
    ds_read_b64_tr_b16 v[122:123], v18 offset:47616
    s_waitcnt lgkmcnt(6)
    v_mfma_f32_32x32x16_bf16 v[72:87], v[108:111], v[156:159], v[72:87]
    ds_read_b64_tr_b16 v[124:125], v19 offset:47104
    ds_read_b64_tr_b16 v[126:127], v19 offset:47616
    s_waitcnt vmcnt(11)
    s_waitcnt lgkmcnt(6)
    v_mfma_f32_32x32x16_bf16 v[56:71], v[112:115], v[160:163], v[56:71]
    ds_read_b64_tr_b16 v[96:97], v18 offset:49152
    ds_read_b64_tr_b16 v[98:99], v18 offset:49664
    s_mov_b32 s57, 65536
    buffer_load_dwordx4 v[152:155], v12, s[24:27], s57 offen sc1
    s_waitcnt lgkmcnt(6)
    v_mfma_f32_32x32x16_bf16 v[72:87], v[116:119], v[160:163], v[72:87]
    ds_read_b64_tr_b16 v[100:101], v19 offset:49152
    ds_read_b64_tr_b16 v[102:103], v19 offset:49664
    buffer_load_dwordx4 v[156:159], v13, s[24:27], s57 offen sc1
    s_waitcnt vmcnt(12)
    s_waitcnt lgkmcnt(6)
    v_mfma_f32_32x32x16_bf16 v[56:71], v[120:123], v[164:167], v[56:71]
    ds_read_b64_tr_b16 v[104:105], v18 offset:51200
    ds_read_b64_tr_b16 v[106:107], v18 offset:51712
    s_waitcnt lgkmcnt(6)
    v_mfma_f32_32x32x16_bf16 v[72:87], v[124:127], v[164:167], v[72:87]
    ds_read_b64_tr_b16 v[108:109], v19 offset:51200
    ds_read_b64_tr_b16 v[110:111], v19 offset:51712
    s_waitcnt vmcnt(11)
    s_waitcnt lgkmcnt(6)
    v_mfma_f32_32x32x16_bf16 v[56:71], v[96:99], v[168:171], v[56:71]
    ds_read_b64_tr_b16 v[112:113], v18 offset:53248
    ds_read_b64_tr_b16 v[114:115], v18 offset:53760
    s_mov_b32 s57, 131072
    buffer_load_dwordx4 v[160:163], v12, s[24:27], s57 offen sc1
    s_waitcnt lgkmcnt(6)
    v_mfma_f32_32x32x16_bf16 v[72:87], v[100:103], v[168:171], v[72:87]
    ds_read_b64_tr_b16 v[116:117], v19 offset:53248
    ds_read_b64_tr_b16 v[118:119], v19 offset:53760
    buffer_load_dwordx4 v[164:167], v13, s[24:27], s57 offen sc1
    s_waitcnt vmcnt(12)
    s_waitcnt lgkmcnt(6)
    v_mfma_f32_32x32x16_bf16 v[56:71], v[104:107], v[172:175], v[56:71]
    ds_read_b64_tr_b16 v[120:121], v18 offset:55296
    ds_read_b64_tr_b16 v[122:123], v18 offset:55808
    s_waitcnt lgkmcnt(6)
    v_mfma_f32_32x32x16_bf16 v[72:87], v[108:111], v[172:175], v[72:87]
    ds_read_b64_tr_b16 v[124:125], v19 offset:55296
    ds_read_b64_tr_b16 v[126:127], v19 offset:55808
    s_waitcnt vmcnt(11)
    s_waitcnt lgkmcnt(6)
    v_mfma_f32_32x32x16_bf16 v[56:71], v[112:115], v[176:179], v[56:71]
    ds_read_b64_tr_b16 v[96:97], v18 offset:57344
    ds_read_b64_tr_b16 v[98:99], v18 offset:57856
    s_mov_b32 s57, 196608
    buffer_load_dwordx4 v[168:171], v12, s[24:27], s57 offen sc1
    s_waitcnt lgkmcnt(6)
    v_mfma_f32_32x32x16_bf16 v[72:87], v[116:119], v[176:179], v[72:87]
    ds_read_b64_tr_b16 v[100:101], v19 offset:57344
    ds_read_b64_tr_b16 v[102:103], v19 offset:57856
    buffer_load_dwordx4 v[172:175], v13, s[24:27], s57 offen sc1
    s_waitcnt vmcnt(12)
    s_waitcnt lgkmcnt(6)
    v_mfma_f32_32x32x16_bf16 v[56:71], v[120:123], v[180:183], v[56:71]
    ds_read_b64_tr_b16 v[104:105], v18 offset:59392
    ds_read_b64_tr_b16 v[106:107], v18 offset:59904
    s_waitcnt lgkmcnt(6)
    v_mfma_f32_32x32x16_bf16 v[72:87], v[124:127], v[180:183], v[72:87]
    ds_read_b64_tr_b16 v[108:109], v19 offset:59392
    ds_read_b64_tr_b16 v[110:111], v19 offset:59904
    s_waitcnt vmcnt(11)
    s_waitcnt lgkmcnt(6)
    v_mfma_f32_32x32x16_bf16 v[56:71], v[96:99], v[128:131], v[56:71]
    ds_read_b64_tr_b16 v[112:113], v18 offset:61440
    ds_read_b64_tr_b16 v[114:115], v18 offset:61952
    s_mov_b32 s57, 262144
    buffer_load_dwordx4 v[176:179], v12, s[24:27], s57 offen sc1
    s_waitcnt lgkmcnt(6)
    v_mfma_f32_32x32x16_bf16 v[72:87], v[100:103], v[128:131], v[72:87]
    ds_read_b64_tr_b16 v[116:117], v19 offset:61440
    ds_read_b64_tr_b16 v[118:119], v19 offset:61952
    buffer_load_dwordx4 v[180:183], v13, s[24:27], s57 offen sc1
    s_waitcnt vmcnt(12)
    s_waitcnt lgkmcnt(6)
    v_mfma_f32_32x32x16_bf16 v[56:71], v[104:107], v[132:135], v[56:71]
    ds_read_b64_tr_b16 v[120:121], v18 offset:63488
    ds_read_b64_tr_b16 v[122:123], v18 offset:64000
    s_waitcnt lgkmcnt(6)
    v_mfma_f32_32x32x16_bf16 v[72:87], v[108:111], v[132:135], v[72:87]
    ds_read_b64_tr_b16 v[124:125], v19 offset:63488
    ds_read_b64_tr_b16 v[126:127], v19 offset:64000
    s_waitcnt vmcnt(11)
    s_waitcnt lgkmcnt(6)
    v_mfma_f32_32x32x16_bf16 v[56:71], v[112:115], v[136:139], v[56:71]
    ds_read_b64_tr_b16 v[96:97], v18 offset:0
    ds_read_b64_tr_b16 v[98:99], v18 offset:512
    s_mov_b32 s57, 327680
    buffer_load_dwordx4 v[128:131], v12, s[24:27], s57 offen sc1
    s_waitcnt lgkmcnt(6)
    v_mfma_f32_32x32x16_bf16 v[72:87], v[116:119], v[136:139], v[72:87]
    ds_read_b64_tr_b16 v[100:101], v19 offset:0
    ds_read_b64_tr_b16 v[102:103], v19 offset:512
    buffer_load_dwordx4 v[132:135], v13, s[24:27], s57 offen sc1
    s_waitcnt vmcnt(12)
    s_waitcnt lgkmcnt(6)
    v_mfma_f32_32x32x16_bf16 v[56:71], v[120:123], v[140:143], v[56:71]
    ds_read_b64_tr_b16 v[104:105], v18 offset:2048
    ds_read_b64_tr_b16 v[106:107], v18 offset:2560
    s_waitcnt lgkmcnt(6)
    v_mfma_f32_32x32x16_bf16 v[72:87], v[124:127], v[140:143], v[72:87]
    ds_read_b64_tr_b16 v[108:109], v19 offset:2048
    ds_read_b64_tr_b16 v[110:111], v19 offset:2560
    s_waitcnt vmcnt(11)
    s_waitcnt lgkmcnt(6)
    v_mfma_f32_32x32x16_bf16 v[24:39], v[96:99], v[144:147], v[24:39]
    ds_read_b64_tr_b16 v[112:113], v18 offset:4096
    ds_read_b64_tr_b16 v[114:115], v18 offset:4608
    s_mov_b32 s57, 393216
    buffer_load_dwordx4 v[136:139], v12, s[24:27], s57 offen sc1
    s_waitcnt lgkmcnt(6)
    v_mfma_f32_32x32x16_bf16 v[40:55], v[100:103], v[144:147], v[40:55]
    ds_read_b64_tr_b16 v[116:117], v19 offset:4096
    ds_read_b64_tr_b16 v[118:119], v19 offset:4608
    buffer_load_dwordx4 v[140:143], v13, s[24:27], s57 offen sc1
    s_waitcnt vmcnt(12)
    s_waitcnt lgkmcnt(6)
    v_mfma_f32_32x32x16_bf16 v[24:39], v[104:107], v[148:151], v[24:39]
    ds_read_b64_tr_b16 v[120:121], v18 offset:6144
    ds_read_b64_tr_b16 v[122:123], v18 offset:6656
    ds_write_b128 v89, v[72:75] offset:0
    ds_write_b128 v89, v[76:79] offset:1024
    s_waitcnt lgkmcnt(8)
    v_mfma_f32_32x32x16_bf16 v[40:55], v[108:111], v[148:151], v[40:55]
    ds_read_b64_tr_b16 v[124:125], v19 offset:6144
    ds_read_b64_tr_b16 v[126:127], v19 offset:6656
    ds_write_b128 v89, v[80:83] offset:2048
    ds_write_b128 v89, v[84:87] offset:3072
    s_waitcnt lgkmcnt(0)
    s_barrier
    s_waitcnt vmcnt(11)
    v_mfma_f32_32x32x16_bf16 v[24:39], v[112:115], v[152:155], v[24:39]
    ds_read_b64_tr_b16 v[96:97], v18 offset:8192
    ds_read_b64_tr_b16 v[98:99], v18 offset:8704
    s_mov_b32 s57, 458752
    buffer_load_dwordx4 v[144:147], v12, s[24:27], s57 offen sc1
    ds_read_b128 v[72:75], v90 offset:0
    ds_read_b128 v[76:79], v90 offset:1024
    v_mfma_f32_32x32x16_bf16 v[40:55], v[116:119], v[152:155], v[40:55]
    ds_read_b64_tr_b16 v[100:101], v19 offset:8192
    ds_read_b64_tr_b16 v[102:103], v19 offset:8704
    buffer_load_dwordx4 v[148:151], v13, s[24:27], s57 offen sc1
    ds_read_b128 v[80:83], v90 offset:2048
    ds_read_b128 v[84:87], v90 offset:3072
    s_waitcnt vmcnt(12)
    v_mfma_f32_32x32x16_bf16 v[24:39], v[120:123], v[156:159], v[24:39]
    ds_read_b64_tr_b16 v[104:105], v18 offset:10240
    ds_read_b64_tr_b16 v[106:107], v18 offset:10752
    v_mfma_f32_32x32x16_bf16 v[40:55], v[124:127], v[156:159], v[40:55]
    ds_read_b64_tr_b16 v[108:109], v19 offset:10240
    ds_read_b64_tr_b16 v[110:111], v19 offset:10752
    s_waitcnt lgkmcnt(9)
    v_add_f32 v56, v56, v72
    v_add_f32 v57, v57, v73
    v_add_f32 v58, v58, v74
    v_add_f32 v59, v59, v75
    s_waitcnt vmcnt(11)
    v_mfma_f32_32x32x16_bf16 v[24:39], v[96:99], v[160:163], v[24:39]
    ds_read_b64_tr_b16 v[112:113], v18 offset:12288
    ds_read_b64_tr_b16 v[114:115], v18 offset:12800
    s_mov_b32 s57, 524288
    buffer_load_dwordx4 v[152:155], v12, s[24:27], s57 offen sc1
    v_bfi_b32 v56, v95, s20, v56
    v_bfi_b32 v57, v95, s21, v57
    v_bfi_b32 v58, v95, s22, v58
    v_bfi_b32 v59, v95, s23, v59
    buffer_store_dwordx4 v[56:59], v94, s[28:31], 0 offen offset:0 sc1
    s_waitcnt lgkmcnt(8)
    v_mfma_f32_32x32x16_bf16 v[40:55], v[100:103], v[160:163], v[40:55]
    ds_read_b64_tr_b16 v[116:117], v19 offset:12288
    ds_read_b64_tr_b16 v[118:119], v19 offset:12800
    buffer_load_dwordx4 v[156:159], v13, s[24:27], s57 offen sc1
    v_add_f32 v60, v60, v76
    v_add_f32 v61, v61, v77
    v_add_f32 v62, v62, v78
    v_add_f32 v63, v63, v79
    s_waitcnt vmcnt(13)
    s_waitcnt lgkmcnt(6)
    v_mfma_f32_32x32x16_bf16 v[24:39], v[104:107], v[164:167], v[24:39]
    ds_read_b64_tr_b16 v[120:121], v18 offset:14336
    ds_read_b64_tr_b16 v[122:123], v18 offset:14848
    v_bfi_b32 v60, v95, s20, v60
    v_bfi_b32 v61, v95, s21, v61
    v_bfi_b32 v62, v95, s22, v62
    v_bfi_b32 v63, v95, s23, v63
    buffer_store_dwordx4 v[60:63], v94, s[28:31], 0 offen offset:1024 sc1
    s_waitcnt lgkmcnt(6)
    v_mfma_f32_32x32x16_bf16 v[40:55], v[108:111], v[164:167], v[40:55]
    ds_read_b64_tr_b16 v[124:125], v19 offset:14336
    ds_read_b64_tr_b16 v[126:127], v19 offset:14848
    v_add_f32 v64, v64, v80
    v_add_f32 v65, v65, v81
    v_add_f32 v66, v66, v82
    v_add_f32 v67, v67, v83
    s_waitcnt vmcnt(13)
    s_waitcnt lgkmcnt(6)
    v_mfma_f32_32x32x16_bf16 v[24:39], v[112:115], v[168:171], v[24:39]
    ds_read_b64_tr_b16 v[96:97], v18 offset:16384
    ds_read_b64_tr_b16 v[98:99], v18 offset:16896
    s_mov_b32 s57, 589824
    buffer_load_dwordx4 v[160:163], v12, s[24:27], s57 offen sc1
    v_bfi_b32 v64, v95, s20, v64
    v_bfi_b32 v65, v95, s21, v65
    v_bfi_b32 v66, v95, s22, v66
    v_bfi_b32 v67, v95, s23, v67
    buffer_store_dwordx4 v[64:67], v94, s[28:31], 0 offen offset:2048 sc1
    s_waitcnt lgkmcnt(6)
    v_mfma_f32_32x32x16_bf16 v[40:55], v[116:119], v[168:171], v[40:55]
    ds_read_b64_tr_b16 v[100:101], v19 offset:16384
    ds_read_b64_tr_b16 v[102:103], v19 offset:16896
    buffer_load_dwordx4 v[164:167], v13, s[24:27], s57 offen sc1
    v_add_f32 v68, v68, v84
    v_add_f32 v69, v69, v85
    v_add_f32 v70, v70, v86
    v_add_f32 v71, v71, v87
    s_waitcnt vmcnt(15)
    s_waitcnt lgkmcnt(6)
    v_mfma_f32_32x32x16_bf16 v[24:39], v[120:123], v[172:175], v[24:39]
    ds_read_b64_tr_b16 v[104:105], v18 offset:18432
    ds_read_b64_tr_b16 v[106:107], v18 offset:18944
    v_bfi_b32 v68, v95, s20, v68
    v_bfi_b32 v69, v95, s21, v69
    v_bfi_b32 v70, v95, s22, v70
    v_bfi_b32 v71, v95, s23, v71
    buffer_store_dwordx4 v[68:71], v94, s[28:31], 0 offen offset:3072 sc1
    s_waitcnt lgkmcnt(6)
    v_mfma_f32_32x32x16_bf16 v[40:55], v[124:127], v[172:175], v[40:55]
    ds_read_b64_tr_b16 v[108:109], v19 offset:18432
    ds_read_b64_tr_b16 v[110:111], v19 offset:18944
    s_waitcnt vmcnt(15)
    s_waitcnt lgkmcnt(6)
    v_mfma_f32_32x32x16_bf16 v[24:39], v[96:99], v[176:179], v[24:39]
    ds_read_b64_tr_b16 v[112:113], v18 offset:20480
    ds_read_b64_tr_b16 v[114:115], v18 offset:20992
    s_mov_b32 s57, 655360
    buffer_load_dwordx4 v[168:171], v12, s[24:27], s57 offen sc1
    s_waitcnt lgkmcnt(6)
    v_mfma_f32_32x32x16_bf16 v[40:55], v[100:103], v[176:179], v[40:55]
    ds_read_b64_tr_b16 v[116:117], v19 offset:20480
    ds_read_b64_tr_b16 v[118:119], v19 offset:20992
    buffer_load_dwordx4 v[172:175], v13, s[24:27], s57 offen sc1
    s_waitcnt vmcnt(16)
    s_waitcnt lgkmcnt(6)
    v_mfma_f32_32x32x16_bf16 v[24:39], v[104:107], v[180:183], v[24:39]
    ds_read_b64_tr_b16 v[120:121], v18 offset:22528
    ds_read_b64_tr_b16 v[122:123], v18 offset:23040
    s_waitcnt lgkmcnt(6)
    v_mfma_f32_32x32x16_bf16 v[40:55], v[108:111], v[180:183], v[40:55]
    ds_read_b64_tr_b16 v[124:125], v19 offset:22528
    ds_read_b64_tr_b16 v[126:127], v19 offset:23040
    s_waitcnt vmcnt(15)
    s_waitcnt lgkmcnt(6)
    v_mfma_f32_32x32x16_bf16 v[24:39], v[112:115], v[128:131], v[24:39]
    ds_read_b64_tr_b16 v[96:97], v18 offset:24576
    ds_read_b64_tr_b16 v[98:99], v18 offset:25088
    s_mov_b32 s57, 720896
    buffer_load_dwordx4 v[176:179], v12, s[24:27], s57 offen sc1
    s_waitcnt lgkmcnt(6)
    v_mfma_f32_32x32x16_bf16 v[40:55], v[116:119], v[128:131], v[40:55]
    ds_read_b64_tr_b16 v[100:101], v19 offset:24576
    ds_read_b64_tr_b16 v[102:103], v19 offset:25088
    buffer_load_dwordx4 v[180:183], v13, s[24:27], s57 offen sc1
    s_waitcnt vmcnt(16)
    s_waitcnt lgkmcnt(6)
    v_mfma_f32_32x32x16_bf16 v[24:39], v[120:123], v[132:135], v[24:39]
    ds_read_b64_tr_b16 v[104:105], v18 offset:26624
    ds_read_b64_tr_b16 v[106:107], v18 offset:27136
    s_waitcnt lgkmcnt(6)
    v_mfma_f32_32x32x16_bf16 v[40:55], v[124:127], v[132:135], v[40:55]
    ds_read_b64_tr_b16 v[108:109], v19 offset:26624
    ds_read_b64_tr_b16 v[110:111], v19 offset:27136
    s_waitcnt vmcnt(15)
    s_waitcnt lgkmcnt(6)
    v_mfma_f32_32x32x16_bf16 v[24:39], v[96:99], v[136:139], v[24:39]
    ds_read_b64_tr_b16 v[112:113], v18 offset:28672
    ds_read_b64_tr_b16 v[114:115], v18 offset:29184
    s_mov_b32 s57, 786432
    buffer_load_dwordx4 v[128:131], v12, s[24:27], s57 offen sc1
    s_waitcnt lgkmcnt(6)
    v_mfma_f32_32x32x16_bf16 v[40:55], v[100:103], v[136:139], v[40:55]
    ds_read_b64_tr_b16 v[116:117], v19 offset:28672
    ds_read_b64_tr_b16 v[118:119], v19 offset:29184
    buffer_load_dwordx4 v[132:135], v13, s[24:27], s57 offen sc1
    s_waitcnt vmcnt(16)
    s_waitcnt lgkmcnt(6)
    v_mfma_f32_32x32x16_bf16 v[24:39], v[104:107], v[140:143], v[24:39]
    ds_read_b64_tr_b16 v[120:121], v18 offset:30720
    ds_read_b64_tr_b16 v[122:123], v18 offset:31232
    s_waitcnt lgkmcnt(6)
    v_mfma_f32_32x32x16_bf16 v[40:55], v[108:111], v[140:143], v[40:55]
    ds_read_b64_tr_b16 v[124:125], v19 offset:30720
    ds_read_b64_tr_b16 v[126:127], v19 offset:31232
    s_waitcnt vmcnt(15)
    s_waitcnt lgkmcnt(6)
    v_mfma_f32_32x32x16_bf16 v[24:39], v[112:115], v[144:147], v[24:39]
    ds_read_b64_tr_b16 v[96:97], v18 offset:32768
    ds_read_b64_tr_b16 v[98:99], v18 offset:33280
    s_mov_b32 s57, 851968
    buffer_load_dwordx4 v[136:139], v12, s[24:27], s57 offen sc1
    s_waitcnt lgkmcnt(6)
    v_mfma_f32_32x32x16_bf16 v[40:55], v[116:119], v[144:147], v[40:55]
    ds_read_b64_tr_b16 v[100:101], v19 offset:32768
    ds_read_b64_tr_b16 v[102:103], v19 offset:33280
    buffer_load_dwordx4 v[140:143], v13, s[24:27], s57 offen sc1
    s_waitcnt vmcnt(16)
    s_waitcnt lgkmcnt(6)
    v_mfma_f32_32x32x16_bf16 v[24:39], v[120:123], v[148:151], v[24:39]
    ds_read_b64_tr_b16 v[104:105], v18 offset:34816
    ds_read_b64_tr_b16 v[106:107], v18 offset:35328
    s_waitcnt lgkmcnt(6)
    v_mfma_f32_32x32x16_bf16 v[40:55], v[124:127], v[148:151], v[40:55]
    ds_read_b64_tr_b16 v[108:109], v19 offset:34816
    ds_read_b64_tr_b16 v[110:111], v19 offset:35328
    s_waitcnt vmcnt(15)
    s_waitcnt lgkmcnt(6)
    v_mfma_f32_32x32x16_bf16 v[24:39], v[96:99], v[152:155], v[24:39]
    ds_read_b64_tr_b16 v[112:113], v18 offset:36864
    ds_read_b64_tr_b16 v[114:115], v18 offset:37376
    s_mov_b32 s57, 917504
    buffer_load_dwordx4 v[144:147], v12, s[24:27], s57 offen sc1
    s_waitcnt lgkmcnt(6)
    v_mfma_f32_32x32x16_bf16 v[40:55], v[100:103], v[152:155], v[40:55]
    ds_read_b64_tr_b16 v[116:117], v19 offset:36864
    ds_read_b64_tr_b16 v[118:119], v19 offset:37376
    buffer_load_dwordx4 v[148:151], v13, s[24:27], s57 offen sc1
    s_waitcnt vmcnt(15)
    s_waitcnt lgkmcnt(6)
    v_mfma_f32_32x32x16_bf16 v[24:39], v[104:107], v[156:159], v[24:39]
    ds_read_b64_tr_b16 v[120:121], v18 offset:38912
    ds_read_b64_tr_b16 v[122:123], v18 offset:39424
    s_waitcnt lgkmcnt(6)
    v_mfma_f32_32x32x16_bf16 v[40:55], v[108:111], v[156:159], v[40:55]
    ds_read_b64_tr_b16 v[124:125], v19 offset:38912
    ds_read_b64_tr_b16 v[126:127], v19 offset:39424
    s_waitcnt vmcnt(13)
    s_waitcnt lgkmcnt(6)
    v_mfma_f32_32x32x16_bf16 v[24:39], v[112:115], v[160:163], v[24:39]
    ds_read_b64_tr_b16 v[96:97], v18 offset:40960
    ds_read_b64_tr_b16 v[98:99], v18 offset:41472
    s_mov_b32 s57, 983040
    buffer_load_dwordx4 v[152:155], v12, s[24:27], s57 offen sc1
    s_waitcnt lgkmcnt(6)
    v_mfma_f32_32x32x16_bf16 v[40:55], v[116:119], v[160:163], v[40:55]
    ds_read_b64_tr_b16 v[100:101], v19 offset:40960
    ds_read_b64_tr_b16 v[102:103], v19 offset:41472
    buffer_load_dwordx4 v[156:159], v13, s[24:27], s57 offen sc1
    s_waitcnt vmcnt(13)
    s_waitcnt lgkmcnt(6)
    v_mfma_f32_32x32x16_bf16 v[24:39], v[120:123], v[164:167], v[24:39]
    ds_read_b64_tr_b16 v[104:105], v18 offset:43008
    ds_read_b64_tr_b16 v[106:107], v18 offset:43520
    s_waitcnt lgkmcnt(6)
    v_mfma_f32_32x32x16_bf16 v[40:55], v[124:127], v[164:167], v[40:55]
    ds_read_b64_tr_b16 v[108:109], v19 offset:43008
    ds_read_b64_tr_b16 v[110:111], v19 offset:43520
    s_barrier
    s_waitcnt vmcnt(11)
    s_waitcnt lgkmcnt(6)
    v_mfma_f32_32x32x16_bf16 v[24:39], v[96:99], v[168:171], v[24:39]
    ds_read_b64_tr_b16 v[112:113], v18 offset:45056
    ds_read_b64_tr_b16 v[114:115], v18 offset:45568
    s_waitcnt lgkmcnt(6)
    v_mfma_f32_32x32x16_bf16 v[40:55], v[100:103], v[168:171], v[40:55]
    ds_read_b64_tr_b16 v[116:117], v19 offset:45056
    ds_read_b64_tr_b16 v[118:119], v19 offset:45568
    s_waitcnt vmcnt(10)
    s_waitcnt lgkmcnt(6)
    v_mfma_f32_32x32x16_bf16 v[24:39], v[104:107], v[172:175], v[24:39]
    ds_read_b64_tr_b16 v[120:121], v18 offset:47104
    ds_read_b64_tr_b16 v[122:123], v18 offset:47616
    s_waitcnt lgkmcnt(6)
    v_mfma_f32_32x32x16_bf16 v[40:55], v[108:111], v[172:175], v[40:55]
    ds_read_b64_tr_b16 v[124:125], v19 offset:47104
    ds_read_b64_tr_b16 v[126:127], v19 offset:47616
    s_waitcnt vmcnt(9)
    s_waitcnt lgkmcnt(6)
    v_mfma_f32_32x32x16_bf16 v[24:39], v[112:115], v[176:179], v[24:39]
    ds_read_b64_tr_b16 v[96:97], v18 offset:49152
    ds_read_b64_tr_b16 v[98:99], v18 offset:49664
    s_waitcnt lgkmcnt(6)
    v_mfma_f32_32x32x16_bf16 v[40:55], v[116:119], v[176:179], v[40:55]
    ds_read_b64_tr_b16 v[100:101], v19 offset:49152
    ds_read_b64_tr_b16 v[102:103], v19 offset:49664
    s_waitcnt vmcnt(8)
    s_waitcnt lgkmcnt(6)
    v_mfma_f32_32x32x16_bf16 v[24:39], v[120:123], v[180:183], v[24:39]
    ds_read_b64_tr_b16 v[104:105], v18 offset:51200
    ds_read_b64_tr_b16 v[106:107], v18 offset:51712
    s_waitcnt lgkmcnt(6)
    v_mfma_f32_32x32x16_bf16 v[40:55], v[124:127], v[180:183], v[40:55]
    ds_read_b64_tr_b16 v[108:109], v19 offset:51200
    ds_read_b64_tr_b16 v[110:111], v19 offset:51712
    s_waitcnt vmcnt(7)
    s_waitcnt lgkmcnt(6)
    v_mfma_f32_32x32x16_bf16 v[24:39], v[96:99], v[128:131], v[24:39]
    ds_read_b64_tr_b16 v[112:113], v18 offset:53248
    ds_read_b64_tr_b16 v[114:115], v18 offset:53760
    buffer_load_dwordx4 v[72:75], v88, s[28:31], 0 offen offset:0 sc1
    s_waitcnt lgkmcnt(6)
    v_mfma_f32_32x32x16_bf16 v[40:55], v[100:103], v[128:131], v[40:55]
    ds_read_b64_tr_b16 v[116:117], v19 offset:53248
    ds_read_b64_tr_b16 v[118:119], v19 offset:53760
    buffer_load_dwordx4 v[76:79], v88, s[28:31], 0 offen offset:1024 sc1
    s_waitcnt vmcnt(8)
    s_waitcnt lgkmcnt(6)
    v_mfma_f32_32x32x16_bf16 v[24:39], v[104:107], v[132:135], v[24:39]
    ds_read_b64_tr_b16 v[120:121], v18 offset:55296
    ds_read_b64_tr_b16 v[122:123], v18 offset:55808
    buffer_load_dwordx4 v[80:83], v88, s[28:31], 0 offen offset:2048 sc1
    s_waitcnt lgkmcnt(6)
    v_mfma_f32_32x32x16_bf16 v[40:55], v[108:111], v[132:135], v[40:55]
    ds_read_b64_tr_b16 v[124:125], v19 offset:55296
    ds_read_b64_tr_b16 v[126:127], v19 offset:55808
    buffer_load_dwordx4 v[84:87], v88, s[28:31], 0 offen offset:3072 sc1
    s_barrier
    s_waitcnt vmcnt(9)
    s_waitcnt lgkmcnt(6)
    v_mfma_f32_32x32x16_bf16 v[24:39], v[112:115], v[136:139], v[24:39]
    ds_read_b64_tr_b16 v[96:97], v18 offset:57344
    ds_read_b64_tr_b16 v[98:99], v18 offset:57856
    s_waitcnt lgkmcnt(6)
    v_mfma_f32_32x32x16_bf16 v[40:55], v[116:119], v[136:139], v[40:55]
    ds_read_b64_tr_b16 v[100:101], v19 offset:57344
    ds_read_b64_tr_b16 v[102:103], v19 offset:57856
    s_waitcnt vmcnt(8)
    s_waitcnt lgkmcnt(6)
    v_mfma_f32_32x32x16_bf16 v[24:39], v[120:123], v[140:143], v[24:39]
    ds_read_b64_tr_b16 v[104:105], v18 offset:59392
    ds_read_b64_tr_b16 v[106:107], v18 offset:59904
    s_waitcnt lgkmcnt(6)
    v_mfma_f32_32x32x16_bf16 v[40:55], v[124:127], v[140:143], v[40:55]
    ds_read_b64_tr_b16 v[108:109], v19 offset:59392
    ds_read_b64_tr_b16 v[110:111], v19 offset:59904
    s_waitcnt vmcnt(7)
    s_waitcnt lgkmcnt(6)
    v_mfma_f32_32x32x16_bf16 v[24:39], v[96:99], v[144:147], v[24:39]
    ds_read_b64_tr_b16 v[112:113], v18 offset:61440
    ds_read_b64_tr_b16 v[114:115], v18 offset:61952
    s_waitcnt lgkmcnt(6)
    v_mfma_f32_32x32x16_bf16 v[40:55], v[100:103], v[144:147], v[40:55]
    ds_read_b64_tr_b16 v[116:117], v19 offset:61440
    ds_read_b64_tr_b16 v[118:119], v19 offset:61952
    s_waitcnt vmcnt(6)
    s_waitcnt lgkmcnt(6)
    v_mfma_f32_32x32x16_bf16 v[24:39], v[104:107], v[148:151], v[24:39]
    ds_read_b64_tr_b16 v[120:121], v18 offset:63488
    ds_read_b64_tr_b16 v[122:123], v18 offset:64000
    s_waitcnt lgkmcnt(6)
    v_mfma_f32_32x32x16_bf16 v[40:55], v[108:111], v[148:151], v[40:55]
    ds_read_b64_tr_b16 v[124:125], v19 offset:63488
    ds_read_b64_tr_b16 v[126:127], v19 offset:64000
    s_waitcnt vmcnt(5)
    s_waitcnt lgkmcnt(4)
    v_mfma_f32_32x32x16_bf16 v[40:55], v[116:119], v[152:155], v[40:55]
    s_waitcnt vmcnt(4)
    s_waitcnt lgkmcnt(0)
    v_mfma_f32_32x32x16_bf16 v[40:55], v[124:127], v[156:159], v[40:55]
    v_mfma_f32_32x32x16_bf16 v[24:39], v[112:115], v[152:155], v[24:39]
    s_nop 6
    v_mfma_f32_32x32x16_bf16 v[24:39], v[120:123], v[156:159], v[24:39]
    s_nop 2
    ds_write_b128 v17, v[40:43] offset:0
    ds_write_b128 v17, v[44:47] offset:1024
    ds_write_b128 v17, v[48:51] offset:2048
    ds_write_b128 v17, v[52:55] offset:3072
    s_waitcnt vmcnt(3)
    v_xor_b32 v72, s20, v72
    v_xor_b32 v73, s21, v73
    v_xor_b32 v74, s22, v74
    v_xor_b32 v75, s23, v75
    v_or3_b32 v4, v72, v73, v74
    v_or_b32 v4, v4, v75
    s_waitcnt vmcnt(2)
    v_xor_b32 v76, s20, v76
    v_xor_b32 v77, s21, v77
    v_xor_b32 v78, s22, v78
    v_xor_b32 v79, s23, v79
    v_or3_b32 v4, v4, v76, v77
    v_or3_b32 v4, v4, v78, v79
    s_waitcnt vmcnt(1)
    v_xor_b32 v80, s20, v80
    v_xor_b32 v81, s21, v81
    v_xor_b32 v82, s22, v82
    v_xor_b32 v83, s23, v83
    v_or3_b32 v4, v4, v80, v81
    v_or3_b32 v4, v4, v82, v83
    s_waitcnt vmcnt(0)
    v_xor_b32 v84, s20, v84
    v_xor_b32 v85, s21, v85
    v_xor_b32 v86, s22, v86
    v_xor_b32 v87, s23, v87
    v_or3_b32 v4, v4, v84, v85
    v_or3_b32 v4, v4, v86, v87
    s_waitcnt lgkmcnt(0)
    s_barrier
    ds_read_b128 v[56:59], v22 offset:0
    ds_read_b128 v[60:63], v22 offset:1024
    ds_read_b128 v[64:67], v22 offset:2048
    ds_read_b128 v[68:71], v22 offset:3072
    s_mov_b32 s58, 0
L_cx:
    v_and_b32 v4, 0xff, v4
    v_cmp_ne_u32 vcc, 0, v4
    s_cbranch_vccz L_cxok
    s_sleep 8

    buffer_load_dwordx4 v[72:75], v88, s[28:31], 0 offen offset:0 sc1
    buffer_load_dwordx4 v[76:79], v88, s[28:31], 0 offen offset:1024 sc1
    buffer_load_dwordx4 v[80:83], v88, s[28:31], 0 offen offset:2048 sc1
    buffer_load_dwordx4 v[84:87], v88, s[28:31], 0 offen offset:3072 sc1
    s_add_u32 s58, s58, 1
    s_waitcnt vmcnt(0)
    v_xor_b32 v72, s20, v72
    v_xor_b32 v73, s21, v73
    v_xor_b32 v74, s22, v74
    v_xor_b32 v75, s23, v75
    v_or3_b32 v4, v72, v73, v74
    v_or_b32 v4, v4, v75
    v_xor_b32 v76, s20, v76
    v_xor_b32 v77, s21, v77
    v_xor_b32 v78, s22, v78
    v_xor_b32 v79, s23, v79
    v_or3_b32 v4, v4, v76, v77
    v_or3_b32 v4, v4, v78, v79
    v_xor_b32 v80, s20, v80
    v_xor_b32 v81, s21, v81
    v_xor_b32 v82, s22, v82
    v_xor_b32 v83, s23, v83
    v_or3_b32 v4, v4, v80, v81
    v_or3_b32 v4, v4, v82, v83
    v_xor_b32 v84, s20, v84
    v_xor_b32 v85, s21, v85
    v_xor_b32 v86, s22, v86
    v_xor_b32 v87, s23, v87
    v_or3_b32 v4, v4, v84, v85
    v_or3_b32 v4, v4, v86, v87
    s_cmp_lt_u32 s58, 20000
    s_cbranch_scc1 L_cx
L_cxok:

    v_pk_add_f32 v[24:25], v[24:25], v[72:73]
    v_pk_add_f32 v[26:27], v[26:27], v[74:75]
    v_pk_add_f32 v[28:29], v[28:29], v[76:77]
    v_pk_add_f32 v[30:31], v[30:31], v[78:79]
    v_pk_add_f32 v[32:33], v[32:33], v[80:81]
    v_pk_add_f32 v[34:35], v[34:35], v[82:83]
    v_pk_add_f32 v[36:37], v[36:37], v[84:85]
    v_pk_add_f32 v[38:39], v[38:39], v[86:87]
    s_waitcnt lgkmcnt(3)
    v_pk_add_f32 v[24:25], v[24:25], v[56:57]
    v_pk_add_f32 v[26:27], v[26:27], v[58:59]
    s_waitcnt lgkmcnt(2)
    v_pk_add_f32 v[28:29], v[28:29], v[60:61]
    v_pk_add_f32 v[30:31], v[30:31], v[62:63]
    v_pk_mul_f32 v[128:129], v[24:25], v[24:25]
    v_pk_mul_f32 v[130:131], v[26:27], v[26:27]
    v_pk_mul_f32 v[132:133], v[28:29], v[28:29]
    v_pk_mul_f32 v[134:135], v[30:31], v[30:31]
    v_pk_fma_f32 v[128:129], v[128:129], s[60:61], v[14:15] op_sel_hi:[1,0,1]
    v_pk_fma_f32 v[130:131], v[130:131], s[60:61], v[14:15] op_sel_hi:[1,0,1]
    v_pk_fma_f32 v[132:133], v[132:133], s[60:61], v[14:15] op_sel_hi:[1,0,1]
    v_pk_fma_f32 v[134:135], v[134:135], s[60:61], v[14:15] op_sel_hi:[1,0,1]
    v_pk_mul_f32 v[128:129], v[128:129], v[24:25]
    v_pk_mul_f32 v[130:131], v[130:131], v[26:27]
    v_pk_mul_f32 v[132:133], v[132:133], v[28:29]
    v_pk_mul_f32 v[134:135], v[134:135], v[30:31]
    v_exp_f32 v128, v128
    v_exp_f32 v129, v129
    v_exp_f32 v130, v130
    v_exp_f32 v131, v131
    v_exp_f32 v132, v132
    v_exp_f32 v133, v133
    v_exp_f32 v134, v134
    v_exp_f32 v135, v135
    v_pk_add_f32 v[128:129], v[128:129], 1.0 op_sel_hi:[1,0]
    v_pk_add_f32 v[130:131], v[130:131], 1.0 op_sel_hi:[1,0]
    v_pk_add_f32 v[132:133], v[132:133], 1.0 op_sel_hi:[1,0]
    v_pk_add_f32 v[134:135], v[134:135], 1.0 op_sel_hi:[1,0]
    v_rcp_f32 v128, v128
    v_rcp_f32 v129, v129
    v_rcp_f32 v130, v130
    v_rcp_f32 v131, v131
    v_rcp_f32 v132, v132
    v_rcp_f32 v133, v133
    v_rcp_f32 v134, v134
    v_rcp_f32 v135, v135
    v_pk_mul_f32 v[24:25], v[128:129], v[24:25]
    v_pk_mul_f32 v[26:27], v[130:131], v[26:27]
    v_pk_mul_f32 v[28:29], v[132:133], v[28:29]
    v_pk_mul_f32 v[30:31], v[134:135], v[30:31]
    v_cvt_pk_bf16_f32 v144, v24, v25
    v_cvt_pk_bf16_f32 v145, v26, v27
    v_cvt_pk_bf16_f32 v146, v28, v29
    v_cvt_pk_bf16_f32 v147, v30, v31
    s_nop 1
    v_permlane32_swap_b32 v144, v146
    v_permlane32_swap_b32 v145, v147
    s_mov_b32 s52, 0
    buffer_store_dwordx4 v[144:147], v16, s[32:35], s52 offen sc1
    s_waitcnt lgkmcnt(1)
    v_pk_add_f32 v[32:33], v[32:33], v[64:65]
    v_pk_add_f32 v[34:35], v[34:35], v[66:67]
    s_waitcnt lgkmcnt(0)
    v_pk_add_f32 v[36:37], v[36:37], v[68:69]
    v_pk_add_f32 v[38:39], v[38:39], v[70:71]
    v_pk_mul_f32 v[136:137], v[32:33], v[32:33]
    v_pk_mul_f32 v[138:139], v[34:35], v[34:35]
    v_pk_mul_f32 v[140:141], v[36:37], v[36:37]
    v_pk_mul_f32 v[142:143], v[38:39], v[38:39]
    v_pk_fma_f32 v[136:137], v[136:137], s[60:61], v[14:15] op_sel_hi:[1,0,1]
    v_pk_fma_f32 v[138:139], v[138:139], s[60:61], v[14:15] op_sel_hi:[1,0,1]
    v_pk_fma_f32 v[140:141], v[140:141], s[60:61], v[14:15] op_sel_hi:[1,0,1]
    v_pk_fma_f32 v[142:143], v[142:143], s[60:61], v[14:15] op_sel_hi:[1,0,1]
    v_pk_mul_f32 v[136:137], v[136:137], v[32:33]
    v_pk_mul_f32 v[138:139], v[138:139], v[34:35]
    v_pk_mul_f32 v[140:141], v[140:141], v[36:37]
    v_pk_mul_f32 v[142:143], v[142:143], v[38:39]
    v_exp_f32 v136, v136
    v_exp_f32 v137, v137
    v_exp_f32 v138, v138
    v_exp_f32 v139, v139
    v_exp_f32 v140, v140
    v_exp_f32 v141, v141
    v_exp_f32 v142, v142
    v_exp_f32 v143, v143
    v_pk_add_f32 v[136:137], v[136:137], 1.0 op_sel_hi:[1,0]
    v_pk_add_f32 v[138:139], v[138:139], 1.0 op_sel_hi:[1,0]
    v_pk_add_f32 v[140:141], v[140:141], 1.0 op_sel_hi:[1,0]
    v_pk_add_f32 v[142:143], v[142:143], 1.0 op_sel_hi:[1,0]
    v_rcp_f32 v136, v136
    v_rcp_f32 v137, v137
    v_rcp_f32 v138, v138
    v_rcp_f32 v139, v139
    v_rcp_f32 v140, v140
    v_rcp_f32 v141, v141
    v_rcp_f32 v142, v142
    v_rcp_f32 v143, v143
    v_pk_mul_f32 v[32:33], v[136:137], v[32:33]
    v_pk_mul_f32 v[34:35], v[138:139], v[34:35]
    v_pk_mul_f32 v[36:37], v[140:141], v[36:37]
    v_pk_mul_f32 v[38:39], v[142:143], v[38:39]
    v_cvt_pk_bf16_f32 v148, v32, v33
    v_cvt_pk_bf16_f32 v149, v34, v35
    v_cvt_pk_bf16_f32 v150, v36, v37
    v_cvt_pk_bf16_f32 v151, v38, v39
    s_nop 1
    v_permlane32_swap_b32 v148, v150
    v_permlane32_swap_b32 v149, v151
    s_mov_b32 s52, 16384
    buffer_store_dwordx4 v[148:151], v16, s[32:35], s52 offen sc1
    v_mov_b32 v2, s40
    v_readfirstlane_b32 s3, v23
    s_mov_b32 s63, s40
    s_mov_b64 exec, 1
    s_waitcnt vmcnt(0)
    ds_add_rtn_u32 v92, v91, v92
    s_waitcnt lgkmcnt(0)
    v_cmp_eq_u32 vcc, 3, v92
    s_cbranch_vccz L_nopub2

    buffer_store_dword v2, v23, s[36:39], 0 offen sc1
L_nopub2:
    s_mov_b64 exec, -1

L_g2d:
    s_barrier
    s_and_b32 s53, s45, 7
    s_lshr_b32 s52, s44, 1
    s_lshl_b32 s52, s52, 3
    s_add_u32 s47, s52, s53
    s_lshl_b32 s47, s47, 6
    s_mul_i32 s54, s41, 11
    s_mov_b32 s55, s54
    s_lshl_b32 s52, s41, 2
    s_lshr_b32 s48, s45, 3
    s_add_u32 s48, s48, s52
    s_lshl_b32 s48, s48, 6

    v_lshrrev_b32 v5, 5, v1
    v_and_b32 v6, 31, v1
    v_lshl_add_u32 v4, v5, 9, v6
    v_add_u32 v4, s48, v4
    v_lshlrev_b32 v4, 4, v4
    s_lshl_b32 s52, s50, 9
    s_lshl_b32 s53, s49, 15
    s_add_u32 s52, s52, s53
    v_add_u32 v12, s52, v4
    v_add_u32 v13, 0x4000, v12

    v_bfe_u32 v7, v1, 2, 2
    v_lshl_add_u32 v16, v5, 3, v7
    v_lshlrev_b32 v16, 7, v16
    v_and_b32 v17, 3, v1
    v_lshl_add_u32 v16, v17, 3, v16
    v_bfe_u32 v17, v1, 4, 1
    v_lshl_add_u32 v16, v17, 5, v16
    v_bfe_u32 v17, v1, 3, 1
    v_xor_b32 v17, s49, v17
    v_lshl_add_u32 v16, v17, 6, v16
    s_mul_i32 s52, s49, 81920
    v_add_u32 v18, s52, v16
    v_xor_b32 v19, 64, v18
    v_add_u32 v20, 0x10000, v18
    v_add_u32 v21, 0x10000, v19

    v_lshlrev_b32 v16, 4, v1
    s_mul_i32 s52, s49, 81920
    s_lshl_b32 s53, s50, 12
    s_add_u32 s53, s53, 12288
    s_add_u32 s52, s52, s53
    v_add_u32 v17, s52, v16
    s_xor_b32 s52, s49, 1
    s_mul_i32 s52, s52, 81920
    s_add_u32 s52, s52, s53
    v_add_u32 v22, s52, v16

    s_lshl_b32 s52, s50, 2
    v_add_u32 v4, s52, v5
    v_and_b32 v7, 7, v1
    v_xor_b32 v4, v4, v7
    v_lshlrev_b32 v14, 7, v6
    v_lshl_add_u32 v14, v4, 4, v14
    s_lshl_b32 s52, s49, 12
    s_add_u32 s52, s52, 20480
    v_add_u32 v14, s52, v14
    v_lshrrev_b32 v4, 3, v1
    v_xor_b32 v15, v7, v4
    v_lshlrev_b32 v15, 4, v15
    v_lshl_add_u32 v15, v4, 7, v15
    s_lshl_b32 s52, s46, 11
    s_add_u32 s52, s52, 20480
    v_add_u32 v15, s52, v15
    s_lshl_b32 s52, s46, 4
    s_add_u32 s52, s52, s47
    v_add_u32 v16, s52, v4
    v_lshlrev_b32 v16, 10, v16
    v_lshl_add_u32 v16, v7, 4, v16
    s_lshl_b32 s52, s48, 1
    v_add_u32 v16, s52, v16
    v_xor_b32 v11, 32, v14
    s_mov_b32 s60, 8192

    s_add_u32 s24, s18, 65536
    s_addc_u32 s25, s19, 0
    s_mov_b32 s26, 1409024
    s_mov_b32 s27, 0x20000
    s_mov_b32 s32, s14
    s_mov_b32 s33, s15
    s_mov_b32 s34, 2097152
    s_mov_b32 s35, 0x20000
    v_lshlrev_b32 v24, 16, v93
    v_lshlrev_b32 v25, 16, v93
    v_lshlrev_b32 v26, 16, v93
    v_lshlrev_b32 v27, 16, v93
    v_lshlrev_b32 v28, 16, v93
    v_lshlrev_b32 v29, 16, v93
    v_lshlrev_b32 v30, 16, v93
    v_lshlrev_b32 v31, 16, v93
    v_lshlrev_b32 v32, 16, v93
    v_lshlrev_b32 v33, 16, v93
    v_lshlrev_b32 v34, 16, v93
    v_lshlrev_b32 v35, 16, v93
    v_lshlrev_b32 v36, 16, v93
    v_lshlrev_b32 v37, 16, v93
    v_lshlrev_b32 v38, 16, v93
    v_lshlrev_b32 v39, 16, v93
    v_mov_b32 v40, 0
    v_mov_b32 v41, 0
    v_mov_b32 v42, 0
    v_mov_b32 v43, 0
    v_mov_b32 v44, 0
    v_mov_b32 v45, 0
    v_mov_b32 v46, 0
    v_mov_b32 v47, 0
    v_mov_b32 v48, 0
    v_mov_b32 v49, 0
    v_mov_b32 v50, 0
    v_mov_b32 v51, 0
    v_mov_b32 v52, 0
    v_mov_b32 v53, 0
    v_mov_b32 v54, 0
    v_mov_b32 v55, 0
    s_waitcnt lgkmcnt(0)
    s_barrier
    s_lshl_b32 s57, s55, 16
    buffer_load_dwordx4 v[128:131], v12, s[24:27], s57 offen sc1
    buffer_load_dwordx4 v[132:135], v13, s[24:27], s57 offen sc1
    s_add_u32 s55, s55, 1
    s_cmp_eq_u32 s55, 22
    s_cselect_b32 s55, 0, s55
    s_lshl_b32 s57, s55, 16
    buffer_load_dwordx4 v[136:139], v12, s[24:27], s57 offen sc1
    buffer_load_dwordx4 v[140:143], v13, s[24:27], s57 offen sc1
    s_add_u32 s55, s55, 1
    s_cmp_eq_u32 s55, 22
    s_cselect_b32 s55, 0, s55
    s_lshl_b32 s57, s55, 16
    buffer_load_dwordx4 v[144:147], v12, s[24:27], s57 offen sc1
    buffer_load_dwordx4 v[148:151], v13, s[24:27], s57 offen sc1
    s_add_u32 s55, s55, 1
    s_cmp_eq_u32 s55, 22
    s_cselect_b32 s55, 0, s55
    s_lshl_b32 s57, s55, 16
    buffer_load_dwordx4 v[152:155], v12, s[24:27], s57 offen sc1
    buffer_load_dwordx4 v[156:159], v13, s[24:27], s57 offen sc1
    s_add_u32 s55, s55, 1
    s_cmp_eq_u32 s55, 22
    s_cselect_b32 s55, 0, s55
    s_lshl_b32 s57, s55, 16
    buffer_load_dwordx4 v[160:163], v12, s[24:27], s57 offen sc1
    buffer_load_dwordx4 v[164:167], v13, s[24:27], s57 offen sc1
    s_add_u32 s55, s55, 1
    s_cmp_eq_u32 s55, 22
    s_cselect_b32 s55, 0, s55
    s_lshl_b32 s57, s55, 16
    buffer_load_dwordx4 v[168:171], v12, s[24:27], s57 offen sc1
    buffer_load_dwordx4 v[172:175], v13, s[24:27], s57 offen sc1
    s_add_u32 s55, s55, 1
    s_cmp_eq_u32 s55, 22
    s_cselect_b32 s55, 0, s55
    ds_read_b64_tr_b16 v[96:97], v18 offset:4096
    ds_read_b64_tr_b16 v[98:99], v18 offset:4608
    ds_read_b64_tr_b16 v[100:101], v19 offset:4096
    ds_read_b64_tr_b16 v[102:103], v19 offset:4608
    ds_read_b64_tr_b16 v[104:105], v18 offset:6144
    ds_read_b64_tr_b16 v[106:107], v18 offset:6656
    ds_read_b64_tr_b16 v[108:109], v19 offset:6144
    ds_read_b64_tr_b16 v[110:111], v19 offset:6656
    s_waitcnt vmcnt(11)
    s_waitcnt lgkmcnt(6)
    v_mfma_f32_32x32x16_bf16 v[24:39], v[128:131], v[96:99], v[24:39]
    ds_read_b64_tr_b16 v[112:113], v18 offset:8192
    ds_read_b64_tr_b16 v[114:115], v18 offset:8704
    s_lshl_b32 s57, s55, 16
    buffer_load_dwordx4 v[176:179], v12, s[24:27], s57 offen sc1
    s_waitcnt lgkmcnt(6)
    v_mfma_f32_32x32x16_bf16 v[40:55], v[128:131], v[100:103], v[40:55]
    ds_read_b64_tr_b16 v[116:117], v19 offset:8192
    ds_read_b64_tr_b16 v[118:119], v19 offset:8704
    buffer_load_dwordx4 v[180:183], v13, s[24:27], s57 offen sc1
    s_add_u32 s55, s55, 1
    s_cmp_eq_u32 s55, 22
    s_cselect_b32 s55, 0, s55
    s_waitcnt vmcnt(12)
    s_waitcnt lgkmcnt(6)
    v_mfma_f32_32x32x16_bf16 v[24:39], v[132:135], v[104:107], v[24:39]
    ds_read_b64_tr_b16 v[120:121], v18 offset:10240
    ds_read_b64_tr_b16 v[122:123], v18 offset:10752
    s_waitcnt lgkmcnt(6)
    v_mfma_f32_32x32x16_bf16 v[40:55], v[132:135], v[108:111], v[40:55]
    ds_read_b64_tr_b16 v[124:125], v19 offset:10240
    ds_read_b64_tr_b16 v[126:127], v19 offset:10752
    s_waitcnt vmcnt(11)
    s_waitcnt lgkmcnt(6)
    v_mfma_f32_32x32x16_bf16 v[24:39], v[136:139], v[112:115], v[24:39]
    ds_read_b64_tr_b16 v[96:97], v18 offset:12288
    ds_read_b64_tr_b16 v[98:99], v18 offset:12800
    s_lshl_b32 s57, s55, 16
    buffer_load_dwordx4 v[128:131], v12, s[24:27], s57 offen sc1
    s_waitcnt lgkmcnt(6)
    v_mfma_f32_32x32x16_bf16 v[40:55], v[136:139], v[116:119], v[40:55]
    ds_read_b64_tr_b16 v[100:101], v19 offset:12288
    ds_read_b64_tr_b16 v[102:103], v19 offset:12800
    buffer_load_dwordx4 v[132:135], v13, s[24:27], s57 offen sc1
    s_add_u32 s55, s55, 1
    s_cmp_eq_u32 s55, 22
    s_cselect_b32 s55, 0, s55
    s_waitcnt vmcnt(12)
    s_waitcnt lgkmcnt(6)
    v_mfma_f32_32x32x16_bf16 v[24:39], v[140:143], v[120:123], v[24:39]
    ds_read_b64_tr_b16 v[104:105], v18 offset:14336
    ds_read_b64_tr_b16 v[106:107], v18 offset:14848
    s_waitcnt lgkmcnt(6)
    v_mfma_f32_32x32x16_bf16 v[40:55], v[140:143], v[124:127], v[40:55]
    ds_read_b64_tr_b16 v[108:109], v19 offset:14336
    ds_read_b64_tr_b16 v[110:111], v19 offset:14848
    s_waitcnt vmcnt(11)
    s_waitcnt lgkmcnt(6)
    v_mfma_f32_32x32x16_bf16 v[24:39], v[144:147], v[96:99], v[24:39]
    ds_read_b64_tr_b16 v[112:113], v18 offset:16384
    ds_read_b64_tr_b16 v[114:115], v18 offset:16896
    s_lshl_b32 s57, s55, 16
    buffer_load_dwordx4 v[136:139], v12, s[24:27], s57 offen sc1
    s_waitcnt lgkmcnt(6)
    v_mfma_f32_32x32x16_bf16 v[40:55], v[144:147], v[100:103], v[40:55]
    ds_read_b64_tr_b16 v[116:117], v19 offset:16384
    ds_read_b64_tr_b16 v[118:119], v19 offset:16896
    buffer_load_dwordx4 v[140:143], v13, s[24:27], s57 offen sc1
    s_add_u32 s55, s55, 1
    s_cmp_eq_u32 s55, 22
    s_cselect_b32 s55, 0, s55
    s_waitcnt vmcnt(12)
    s_waitcnt lgkmcnt(6)
    v_mfma_f32_32x32x16_bf16 v[24:39], v[148:151], v[104:107], v[24:39]
    ds_read_b64_tr_b16 v[120:121], v18 offset:18432
    ds_read_b64_tr_b16 v[122:123], v18 offset:18944
    s_waitcnt lgkmcnt(6)
    v_mfma_f32_32x32x16_bf16 v[40:55], v[148:151], v[108:111], v[40:55]
    ds_read_b64_tr_b16 v[124:125], v19 offset:18432
    ds_read_b64_tr_b16 v[126:127], v19 offset:18944
    s_barrier
    s_waitcnt vmcnt(11)
    s_waitcnt lgkmcnt(6)
    v_mfma_f32_32x32x16_bf16 v[24:39], v[152:155], v[112:115], v[24:39]
    ds_read_b64_tr_b16 v[96:97], v18 offset:20480
    ds_read_b64_tr_b16 v[98:99], v18 offset:20992
    s_lshl_b32 s57, s55, 16
    buffer_load_dwordx4 v[144:147], v12, s[24:27], s57 offen sc1
    s_waitcnt lgkmcnt(6)
    v_mfma_f32_32x32x16_bf16 v[40:55], v[152:155], v[116:119], v[40:55]
    ds_read_b64_tr_b16 v[100:101], v19 offset:20480
    ds_read_b64_tr_b16 v[102:103], v19 offset:20992
    buffer_load_dwordx4 v[148:151], v13, s[24:27], s57 offen sc1
    s_add_u32 s55, s55, 1
    s_cmp_eq_u32 s55, 22
    s_cselect_b32 s55, 0, s55
    s_waitcnt vmcnt(12)
    s_waitcnt lgkmcnt(6)
    v_mfma_f32_32x32x16_bf16 v[24:39], v[156:159], v[120:123], v[24:39]
    ds_read_b64_tr_b16 v[104:105], v18 offset:22528
    ds_read_b64_tr_b16 v[106:107], v18 offset:23040
    s_waitcnt lgkmcnt(6)
    v_mfma_f32_32x32x16_bf16 v[40:55], v[156:159], v[124:127], v[40:55]
    ds_read_b64_tr_b16 v[108:109], v19 offset:22528
    ds_read_b64_tr_b16 v[110:111], v19 offset:23040
    s_waitcnt vmcnt(11)
    s_waitcnt lgkmcnt(6)
    v_mfma_f32_32x32x16_bf16 v[24:39], v[160:163], v[96:99], v[24:39]
    ds_read_b64_tr_b16 v[112:113], v18 offset:24576
    ds_read_b64_tr_b16 v[114:115], v18 offset:25088
    s_lshl_b32 s57, s55, 16
    buffer_load_dwordx4 v[152:155], v12, s[24:27], s57 offen sc1
    s_waitcnt lgkmcnt(6)
    v_mfma_f32_32x32x16_bf16 v[40:55], v[160:163], v[100:103], v[40:55]
    ds_read_b64_tr_b16 v[116:117], v19 offset:24576
    ds_read_b64_tr_b16 v[118:119], v19 offset:25088
    buffer_load_dwordx4 v[156:159], v13, s[24:27], s57 offen sc1
    s_add_u32 s55, s55, 1
    s_cmp_eq_u32 s55, 22
    s_cselect_b32 s55, 0, s55
    s_waitcnt vmcnt(12)
    s_waitcnt lgkmcnt(6)
    v_mfma_f32_32x32x16_bf16 v[24:39], v[164:167], v[104:107], v[24:39]
    ds_read_b64_tr_b16 v[120:121], v18 offset:26624
    ds_read_b64_tr_b16 v[122:123], v18 offset:27136
    s_waitcnt lgkmcnt(6)
    v_mfma_f32_32x32x16_bf16 v[40:55], v[164:167], v[108:111], v[40:55]
    ds_read_b64_tr_b16 v[124:125], v19 offset:26624
    ds_read_b64_tr_b16 v[126:127], v19 offset:27136
    s_waitcnt vmcnt(11)
    s_waitcnt lgkmcnt(6)
    v_mfma_f32_32x32x16_bf16 v[24:39], v[168:171], v[112:115], v[24:39]
    ds_read_b64_tr_b16 v[96:97], v18 offset:28672
    ds_read_b64_tr_b16 v[98:99], v18 offset:29184
    s_lshl_b32 s57, s55, 16
    buffer_load_dwordx4 v[160:163], v12, s[24:27], s57 offen sc1
    s_waitcnt lgkmcnt(6)
    v_mfma_f32_32x32x16_bf16 v[40:55], v[168:171], v[116:119], v[40:55]
    ds_read_b64_tr_b16 v[100:101], v19 offset:28672
    ds_read_b64_tr_b16 v[102:103], v19 offset:29184
    buffer_load_dwordx4 v[164:167], v13, s[24:27], s57 offen sc1
    s_add_u32 s55, s55, 1
    s_cmp_eq_u32 s55, 22
    s_cselect_b32 s55, 0, s55
    s_waitcnt vmcnt(12)
    s_waitcnt lgkmcnt(6)
    v_mfma_f32_32x32x16_bf16 v[24:39], v[172:175], v[120:123], v[24:39]
    ds_read_b64_tr_b16 v[104:105], v18 offset:30720
    ds_read_b64_tr_b16 v[106:107], v18 offset:31232
    s_waitcnt lgkmcnt(6)
    v_mfma_f32_32x32x16_bf16 v[40:55], v[172:175], v[124:127], v[40:55]
    ds_read_b64_tr_b16 v[108:109], v19 offset:30720
    ds_read_b64_tr_b16 v[110:111], v19 offset:31232
    s_waitcnt vmcnt(11)
    s_waitcnt lgkmcnt(6)
    v_mfma_f32_32x32x16_bf16 v[24:39], v[176:179], v[96:99], v[24:39]
    ds_read_b64_tr_b16 v[112:113], v18 offset:32768
    ds_read_b64_tr_b16 v[114:115], v18 offset:33280
    s_lshl_b32 s57, s55, 16
    buffer_load_dwordx4 v[168:171], v12, s[24:27], s57 offen sc1
    s_waitcnt lgkmcnt(6)
    v_mfma_f32_32x32x16_bf16 v[40:55], v[176:179], v[100:103], v[40:55]
    ds_read_b64_tr_b16 v[116:117], v19 offset:32768
    ds_read_b64_tr_b16 v[118:119], v19 offset:33280
    buffer_load_dwordx4 v[172:175], v13, s[24:27], s57 offen sc1
    s_add_u32 s55, s55, 1
    s_cmp_eq_u32 s55, 22
    s_cselect_b32 s55, 0, s55
    s_waitcnt vmcnt(12)
    s_waitcnt lgkmcnt(6)
    v_mfma_f32_32x32x16_bf16 v[24:39], v[180:183], v[104:107], v[24:39]
    ds_read_b64_tr_b16 v[120:121], v18 offset:34816
    ds_read_b64_tr_b16 v[122:123], v18 offset:35328
    s_waitcnt lgkmcnt(6)
    v_mfma_f32_32x32x16_bf16 v[40:55], v[180:183], v[108:111], v[40:55]
    ds_read_b64_tr_b16 v[124:125], v19 offset:34816
    ds_read_b64_tr_b16 v[126:127], v19 offset:35328
    s_waitcnt vmcnt(11)
    s_waitcnt lgkmcnt(6)
    v_mfma_f32_32x32x16_bf16 v[24:39], v[128:131], v[112:115], v[24:39]
    ds_read_b64_tr_b16 v[96:97], v18 offset:36864
    ds_read_b64_tr_b16 v[98:99], v18 offset:37376
    s_lshl_b32 s57, s55, 16
    buffer_load_dwordx4 v[176:179], v12, s[24:27], s57 offen sc1
    s_waitcnt lgkmcnt(6)
    v_mfma_f32_32x32x16_bf16 v[40:55], v[128:131], v[116:119], v[40:55]
    ds_read_b64_tr_b16 v[100:101], v19 offset:36864
    ds_read_b64_tr_b16 v[102:103], v19 offset:37376
    buffer_load_dwordx4 v[180:183], v13, s[24:27], s57 offen sc1
    s_add_u32 s55, s55, 1
    s_cmp_eq_u32 s55, 22
    s_cselect_b32 s55, 0, s55
    s_waitcnt vmcnt(12)
    s_waitcnt lgkmcnt(6)
    v_mfma_f32_32x32x16_bf16 v[24:39], v[132:135], v[120:123], v[24:39]
    ds_read_b64_tr_b16 v[104:105], v18 offset:38912
    ds_read_b64_tr_b16 v[106:107], v18 offset:39424
    s_waitcnt lgkmcnt(6)
    v_mfma_f32_32x32x16_bf16 v[40:55], v[132:135], v[124:127], v[40:55]
    ds_read_b64_tr_b16 v[108:109], v19 offset:38912
    ds_read_b64_tr_b16 v[110:111], v19 offset:39424
    s_waitcnt vmcnt(11)
    s_waitcnt lgkmcnt(6)
    v_mfma_f32_32x32x16_bf16 v[24:39], v[136:139], v[96:99], v[24:39]
    ds_read_b64_tr_b16 v[112:113], v18 offset:40960
    ds_read_b64_tr_b16 v[114:115], v18 offset:41472
    s_lshl_b32 s57, s55, 16
    buffer_load_dwordx4 v[128:131], v12, s[24:27], s57 offen sc1
    s_waitcnt lgkmcnt(6)
    v_mfma_f32_32x32x16_bf16 v[40:55], v[136:139], v[100:103], v[40:55]
    ds_read_b64_tr_b16 v[116:117], v19 offset:40960
    ds_read_b64_tr_b16 v[118:119], v19 offset:41472
    buffer_load_dwordx4 v[132:135], v13, s[24:27], s57 offen sc1
    s_add_u32 s55, s55, 1
    s_cmp_eq_u32 s55, 22
    s_cselect_b32 s55, 0, s55
    s_waitcnt vmcnt(12)
    s_waitcnt lgkmcnt(6)
    v_mfma_f32_32x32x16_bf16 v[24:39], v[140:143], v[104:107], v[24:39]
    ds_read_b64_tr_b16 v[120:121], v18 offset:43008
    ds_read_b64_tr_b16 v[122:123], v18 offset:43520
    s_waitcnt lgkmcnt(6)
    v_mfma_f32_32x32x16_bf16 v[40:55], v[140:143], v[108:111], v[40:55]
    ds_read_b64_tr_b16 v[124:125], v19 offset:43008
    ds_read_b64_tr_b16 v[126:127], v19 offset:43520
    s_waitcnt vmcnt(11)
    s_waitcnt lgkmcnt(6)
    v_mfma_f32_32x32x16_bf16 v[24:39], v[144:147], v[112:115], v[24:39]
    ds_read_b64_tr_b16 v[96:97], v18 offset:45056
    ds_read_b64_tr_b16 v[98:99], v18 offset:45568
    s_lshl_b32 s57, s55, 16
    buffer_load_dwordx4 v[136:139], v12, s[24:27], s57 offen sc1
    s_waitcnt lgkmcnt(6)
    v_mfma_f32_32x32x16_bf16 v[40:55], v[144:147], v[116:119], v[40:55]
    ds_read_b64_tr_b16 v[100:101], v19 offset:45056
    ds_read_b64_tr_b16 v[102:103], v19 offset:45568
    buffer_load_dwordx4 v[140:143], v13, s[24:27], s57 offen sc1
    s_add_u32 s55, s55, 1
    s_cmp_eq_u32 s55, 22
    s_cselect_b32 s55, 0, s55
    s_waitcnt vmcnt(12)
    s_waitcnt lgkmcnt(6)
    v_mfma_f32_32x32x16_bf16 v[24:39], v[148:151], v[120:123], v[24:39]
    ds_read_b64_tr_b16 v[104:105], v18 offset:47104
    ds_read_b64_tr_b16 v[106:107], v18 offset:47616
    s_waitcnt lgkmcnt(6)
    v_mfma_f32_32x32x16_bf16 v[40:55], v[148:151], v[124:127], v[40:55]
    ds_read_b64_tr_b16 v[108:109], v19 offset:47104
    ds_read_b64_tr_b16 v[110:111], v19 offset:47616
    s_waitcnt vmcnt(11)
    s_waitcnt lgkmcnt(6)
    v_mfma_f32_32x32x16_bf16 v[24:39], v[152:155], v[96:99], v[24:39]
    ds_read_b64_tr_b16 v[112:113], v18 offset:49152
    ds_read_b64_tr_b16 v[114:115], v18 offset:49664
    s_lshl_b32 s57, s55, 16
    buffer_load_dwordx4 v[144:147], v12, s[24:27], s57 offen sc1
    s_waitcnt lgkmcnt(6)
    v_mfma_f32_32x32x16_bf16 v[40:55], v[152:155], v[100:103], v[40:55]
    ds_read_b64_tr_b16 v[116:117], v19 offset:49152
    ds_read_b64_tr_b16 v[118:119], v19 offset:49664
    buffer_load_dwordx4 v[148:151], v13, s[24:27], s57 offen sc1
    s_add_u32 s55, s55, 1
    s_cmp_eq_u32 s55, 22
    s_cselect_b32 s55, 0, s55
    s_waitcnt vmcnt(12)
    s_waitcnt lgkmcnt(6)
    v_mfma_f32_32x32x16_bf16 v[24:39], v[156:159], v[104:107], v[24:39]
    ds_read_b64_tr_b16 v[120:121], v18 offset:51200
    ds_read_b64_tr_b16 v[122:123], v18 offset:51712
    s_waitcnt lgkmcnt(6)
    v_mfma_f32_32x32x16_bf16 v[40:55], v[156:159], v[108:111], v[40:55]
    ds_read_b64_tr_b16 v[124:125], v19 offset:51200
    ds_read_b64_tr_b16 v[126:127], v19 offset:51712
    s_waitcnt vmcnt(11)
    s_waitcnt lgkmcnt(6)
    v_mfma_f32_32x32x16_bf16 v[24:39], v[160:163], v[112:115], v[24:39]
    ds_read_b64_tr_b16 v[96:97], v18 offset:53248
    ds_read_b64_tr_b16 v[98:99], v18 offset:53760
    s_lshl_b32 s57, s55, 16
    buffer_load_dwordx4 v[152:155], v12, s[24:27], s57 offen sc1
    s_waitcnt lgkmcnt(6)
    v_mfma_f32_32x32x16_bf16 v[40:55], v[160:163], v[116:119], v[40:55]
    ds_read_b64_tr_b16 v[100:101], v19 offset:53248
    ds_read_b64_tr_b16 v[102:103], v19 offset:53760
    buffer_load_dwordx4 v[156:159], v13, s[24:27], s57 offen sc1
    s_add_u32 s55, s55, 1
    s_cmp_eq_u32 s55, 22
    s_cselect_b32 s55, 0, s55
    s_waitcnt vmcnt(12)
    s_waitcnt lgkmcnt(6)
    v_mfma_f32_32x32x16_bf16 v[24:39], v[164:167], v[120:123], v[24:39]
    ds_read_b64_tr_b16 v[104:105], v18 offset:55296
    ds_read_b64_tr_b16 v[106:107], v18 offset:55808
    s_waitcnt lgkmcnt(6)
    v_mfma_f32_32x32x16_bf16 v[40:55], v[164:167], v[124:127], v[40:55]
    ds_read_b64_tr_b16 v[108:109], v19 offset:55296
    ds_read_b64_tr_b16 v[110:111], v19 offset:55808
    s_waitcnt vmcnt(11)
    s_waitcnt lgkmcnt(6)
    v_mfma_f32_32x32x16_bf16 v[24:39], v[168:171], v[96:99], v[24:39]
    ds_read_b64_tr_b16 v[112:113], v18 offset:57344
    ds_read_b64_tr_b16 v[114:115], v18 offset:57856
    s_lshl_b32 s57, s55, 16
    buffer_load_dwordx4 v[160:163], v12, s[24:27], s57 offen sc1
    s_waitcnt lgkmcnt(6)
    v_mfma_f32_32x32x16_bf16 v[40:55], v[168:171], v[100:103], v[40:55]
    ds_read_b64_tr_b16 v[116:117], v19 offset:57344
    ds_read_b64_tr_b16 v[118:119], v19 offset:57856
    buffer_load_dwordx4 v[164:167], v13, s[24:27], s57 offen sc1
    s_add_u32 s55, s55, 1
    s_cmp_eq_u32 s55, 22
    s_cselect_b32 s55, 0, s55
    s_waitcnt vmcnt(12)
    s_waitcnt lgkmcnt(6)
    v_mfma_f32_32x32x16_bf16 v[24:39], v[172:175], v[104:107], v[24:39]
    ds_read_b64_tr_b16 v[120:121], v18 offset:59392
    ds_read_b64_tr_b16 v[122:123], v18 offset:59904
    s_waitcnt lgkmcnt(6)
    v_mfma_f32_32x32x16_bf16 v[40:55], v[172:175], v[108:111], v[40:55]
    ds_read_b64_tr_b16 v[124:125], v19 offset:59392
    ds_read_b64_tr_b16 v[126:127], v19 offset:59904
    s_waitcnt vmcnt(11)
    s_waitcnt lgkmcnt(6)
    v_mfma_f32_32x32x16_bf16 v[24:39], v[176:179], v[112:115], v[24:39]
    ds_read_b64_tr_b16 v[96:97], v18 offset:61440
    ds_read_b64_tr_b16 v[98:99], v18 offset:61952
    s_lshl_b32 s57, s55, 16
    buffer_load_dwordx4 v[168:171], v12, s[24:27], s57 offen sc1
    s_waitcnt lgkmcnt(6)
    v_mfma_f32_32x32x16_bf16 v[40:55], v[176:179], v[116:119], v[40:55]
    ds_read_b64_tr_b16 v[100:101], v19 offset:61440
    ds_read_b64_tr_b16 v[102:103], v19 offset:61952
    buffer_load_dwordx4 v[172:175], v13, s[24:27], s57 offen sc1
    s_add_u32 s55, s55, 1
    s_cmp_eq_u32 s55, 22
    s_cselect_b32 s55, 0, s55
    s_waitcnt vmcnt(12)
    s_waitcnt lgkmcnt(6)
    v_mfma_f32_32x32x16_bf16 v[24:39], v[180:183], v[120:123], v[24:39]
    ds_read_b64_tr_b16 v[104:105], v18 offset:63488
    ds_read_b64_tr_b16 v[106:107], v18 offset:64000
    s_waitcnt lgkmcnt(6)
    v_mfma_f32_32x32x16_bf16 v[40:55], v[180:183], v[124:127], v[40:55]
    ds_read_b64_tr_b16 v[108:109], v19 offset:63488
    ds_read_b64_tr_b16 v[110:111], v19 offset:64000
    s_waitcnt vmcnt(11)
    s_waitcnt lgkmcnt(6)
    v_mfma_f32_32x32x16_bf16 v[24:39], v[128:131], v[96:99], v[24:39]
    ds_read_b64_tr_b16 v[112:113], v20 offset:0
    ds_read_b64_tr_b16 v[114:115], v20 offset:512
    s_lshl_b32 s57, s55, 16
    buffer_load_dwordx4 v[176:179], v12, s[24:27], s57 offen sc1
    s_waitcnt lgkmcnt(6)
    v_mfma_f32_32x32x16_bf16 v[40:55], v[128:131], v[100:103], v[40:55]
    ds_read_b64_tr_b16 v[116:117], v21 offset:0
    ds_read_b64_tr_b16 v[118:119], v21 offset:512
    buffer_load_dwordx4 v[180:183], v13, s[24:27], s57 offen sc1
    s_add_u32 s55, s55, 1
    s_cmp_eq_u32 s55, 22
    s_cselect_b32 s55, 0, s55
    s_waitcnt vmcnt(12)
    s_waitcnt lgkmcnt(6)
    v_mfma_f32_32x32x16_bf16 v[24:39], v[132:135], v[104:107], v[24:39]
    ds_read_b64_tr_b16 v[120:121], v20 offset:2048
    ds_read_b64_tr_b16 v[122:123], v20 offset:2560
    s_waitcnt lgkmcnt(6)
    v_mfma_f32_32x32x16_bf16 v[40:55], v[132:135], v[108:111], v[40:55]
    ds_read_b64_tr_b16 v[124:125], v21 offset:2048
    ds_read_b64_tr_b16 v[126:127], v21 offset:2560
    s_waitcnt vmcnt(11)
    s_waitcnt lgkmcnt(6)
    v_mfma_f32_32x32x16_bf16 v[24:39], v[136:139], v[112:115], v[24:39]
    ds_read_b64_tr_b16 v[96:97], v20 offset:4096
    ds_read_b64_tr_b16 v[98:99], v20 offset:4608
    s_lshl_b32 s57, s55, 16
    buffer_load_dwordx4 v[128:131], v12, s[24:27], s57 offen sc1
    s_waitcnt lgkmcnt(6)
    v_mfma_f32_32x32x16_bf16 v[40:55], v[136:139], v[116:119], v[40:55]
    ds_read_b64_tr_b16 v[100:101], v21 offset:4096
    ds_read_b64_tr_b16 v[102:103], v21 offset:4608
    buffer_load_dwordx4 v[132:135], v13, s[24:27], s57 offen sc1
    s_add_u32 s55, s55, 1
    s_cmp_eq_u32 s55, 22
    s_cselect_b32 s55, 0, s55
    s_waitcnt vmcnt(12)
    s_waitcnt lgkmcnt(6)
    v_mfma_f32_32x32x16_bf16 v[24:39], v[140:143], v[120:123], v[24:39]
    ds_read_b64_tr_b16 v[104:105], v20 offset:6144
    ds_read_b64_tr_b16 v[106:107], v20 offset:6656
    s_waitcnt lgkmcnt(6)
    v_mfma_f32_32x32x16_bf16 v[40:55], v[140:143], v[124:127], v[40:55]
    ds_read_b64_tr_b16 v[108:109], v21 offset:6144
    ds_read_b64_tr_b16 v[110:111], v21 offset:6656
    s_waitcnt vmcnt(11)
    s_waitcnt lgkmcnt(6)
    v_mfma_f32_32x32x16_bf16 v[24:39], v[144:147], v[96:99], v[24:39]
    ds_read_b64_tr_b16 v[112:113], v20 offset:8192
    ds_read_b64_tr_b16 v[114:115], v20 offset:8704
    s_waitcnt lgkmcnt(6)
    v_mfma_f32_32x32x16_bf16 v[40:55], v[144:147], v[100:103], v[40:55]
    ds_read_b64_tr_b16 v[116:117], v21 offset:8192
    ds_read_b64_tr_b16 v[118:119], v21 offset:8704
    s_waitcnt vmcnt(10)
    s_waitcnt lgkmcnt(6)
    v_mfma_f32_32x32x16_bf16 v[24:39], v[148:151], v[104:107], v[24:39]
    ds_read_b64_tr_b16 v[120:121], v20 offset:10240
    ds_read_b64_tr_b16 v[122:123], v20 offset:10752
    s_waitcnt lgkmcnt(6)
    v_mfma_f32_32x32x16_bf16 v[40:55], v[148:151], v[108:111], v[40:55]
    ds_read_b64_tr_b16 v[124:125], v21 offset:10240
    ds_read_b64_tr_b16 v[126:127], v21 offset:10752
    s_waitcnt vmcnt(9)
    s_waitcnt lgkmcnt(6)
    v_mfma_f32_32x32x16_bf16 v[24:39], v[152:155], v[112:115], v[24:39]
    ds_read_b64_tr_b16 v[96:97], v20 offset:12288
    ds_read_b64_tr_b16 v[98:99], v20 offset:12800
    s_waitcnt lgkmcnt(6)
    v_mfma_f32_32x32x16_bf16 v[40:55], v[152:155], v[116:119], v[40:55]
    ds_read_b64_tr_b16 v[100:101], v21 offset:12288
    ds_read_b64_tr_b16 v[102:103], v21 offset:12800
    s_waitcnt vmcnt(8)
    s_waitcnt lgkmcnt(6)
    v_mfma_f32_32x32x16_bf16 v[24:39], v[156:159], v[120:123], v[24:39]
    ds_read_b64_tr_b16 v[104:105], v20 offset:14336
    ds_read_b64_tr_b16 v[106:107], v20 offset:14848
    s_waitcnt lgkmcnt(6)
    v_mfma_f32_32x32x16_bf16 v[40:55], v[156:159], v[124:127], v[40:55]
    ds_read_b64_tr_b16 v[108:109], v21 offset:14336
    ds_read_b64_tr_b16 v[110:111], v21 offset:14848
    s_waitcnt vmcnt(7)
    s_waitcnt lgkmcnt(6)
    v_mfma_f32_32x32x16_bf16 v[24:39], v[160:163], v[96:99], v[24:39]
    ds_read_b64_tr_b16 v[112:113], v18 offset:0
    ds_read_b64_tr_b16 v[114:115], v18 offset:512
    s_waitcnt lgkmcnt(6)
    v_mfma_f32_32x32x16_bf16 v[40:55], v[160:163], v[100:103], v[40:55]
    ds_read_b64_tr_b16 v[116:117], v19 offset:0
    ds_read_b64_tr_b16 v[118:119], v19 offset:512
    s_waitcnt vmcnt(6)
    s_waitcnt lgkmcnt(6)
    v_mfma_f32_32x32x16_bf16 v[24:39], v[164:167], v[104:107], v[24:39]
    ds_read_b64_tr_b16 v[120:121], v18 offset:2048
    ds_read_b64_tr_b16 v[122:123], v18 offset:2560
    s_waitcnt lgkmcnt(6)
    v_mfma_f32_32x32x16_bf16 v[40:55], v[164:167], v[108:111], v[40:55]
    ds_read_b64_tr_b16 v[124:125], v19 offset:2048
    ds_read_b64_tr_b16 v[126:127], v19 offset:2560
    s_barrier
    s_waitcnt vmcnt(5)
    s_waitcnt lgkmcnt(6)
    v_mfma_f32_32x32x16_bf16 v[24:39], v[168:171], v[112:115], v[24:39]
    ds_read_b64_tr_b16 v[96:97], v18 offset:4096
    ds_read_b64_tr_b16 v[98:99], v18 offset:4608
    s_waitcnt lgkmcnt(6)
    v_mfma_f32_32x32x16_bf16 v[40:55], v[168:171], v[116:119], v[40:55]
    ds_read_b64_tr_b16 v[100:101], v19 offset:4096
    ds_read_b64_tr_b16 v[102:103], v19 offset:4608
    s_waitcnt vmcnt(4)
    s_waitcnt lgkmcnt(6)
    v_mfma_f32_32x32x16_bf16 v[24:39], v[172:175], v[120:123], v[24:39]
    ds_read_b64_tr_b16 v[104:105], v18 offset:6144
    ds_read_b64_tr_b16 v[106:107], v18 offset:6656
    s_waitcnt lgkmcnt(6)
    v_mfma_f32_32x32x16_bf16 v[40:55], v[172:175], v[124:127], v[40:55]
    ds_read_b64_tr_b16 v[108:109], v19 offset:6144
    ds_read_b64_tr_b16 v[110:111], v19 offset:6656
    s_waitcnt vmcnt(3)
    s_waitcnt lgkmcnt(6)
    v_mfma_f32_32x32x16_bf16 v[24:39], v[176:179], v[96:99], v[24:39]
    ds_read_b64_tr_b16 v[112:113], v18 offset:8192
    ds_read_b64_tr_b16 v[114:115], v18 offset:8704
    s_waitcnt lgkmcnt(6)
    v_mfma_f32_32x32x16_bf16 v[40:55], v[176:179], v[100:103], v[40:55]
    ds_read_b64_tr_b16 v[116:117], v19 offset:8192
    ds_read_b64_tr_b16 v[118:119], v19 offset:8704
    s_waitcnt vmcnt(2)
    s_waitcnt lgkmcnt(6)
    v_mfma_f32_32x32x16_bf16 v[24:39], v[180:183], v[104:107], v[24:39]
    ds_read_b64_tr_b16 v[120:121], v18 offset:10240
    ds_read_b64_tr_b16 v[122:123], v18 offset:10752
    s_waitcnt lgkmcnt(6)
    v_mfma_f32_32x32x16_bf16 v[40:55], v[180:183], v[108:111], v[40:55]
    ds_read_b64_tr_b16 v[124:125], v19 offset:10240
    ds_read_b64_tr_b16 v[126:127], v19 offset:10752
    s_waitcnt vmcnt(1)
    s_waitcnt lgkmcnt(4)
    v_mfma_f32_32x32x16_bf16 v[40:55], v[128:131], v[116:119], v[40:55]
    s_waitcnt vmcnt(0)
    s_waitcnt lgkmcnt(0)
    v_mfma_f32_32x32x16_bf16 v[40:55], v[132:135], v[124:127], v[40:55]
    v_mfma_f32_32x32x16_bf16 v[24:39], v[128:131], v[112:115], v[24:39]
    s_nop 6
    v_mfma_f32_32x32x16_bf16 v[24:39], v[132:135], v[120:123], v[24:39]
    s_nop 2
    ds_write_b128 v17, v[40:43] offset:0
    ds_write_b128 v17, v[44:47] offset:1024
    ds_write_b128 v17, v[48:51] offset:2048
    ds_write_b128 v17, v[52:55] offset:3072
    s_waitcnt lgkmcnt(0)
    s_barrier
    ds_read_b128 v[56:59], v22 offset:0
    ds_read_b128 v[60:63], v22 offset:1024
    ds_read_b128 v[64:67], v22 offset:2048
    ds_read_b128 v[68:71], v22 offset:3072
    s_waitcnt lgkmcnt(3)
    v_pk_add_f32 v[24:25], v[24:25], v[56:57]
    v_pk_add_f32 v[26:27], v[26:27], v[58:59]
    s_waitcnt lgkmcnt(2)
    v_pk_add_f32 v[28:29], v[28:29], v[60:61]
    v_pk_add_f32 v[30:31], v[30:31], v[62:63]
    v_cvt_pk_bf16_f32 v144, v24, v25
    v_cvt_pk_bf16_f32 v145, v26, v27
    v_cvt_pk_bf16_f32 v146, v28, v29
    v_cvt_pk_bf16_f32 v147, v30, v31
    s_nop 1
    v_permlane32_swap_b32 v144, v146
    v_permlane32_swap_b32 v145, v147
    ds_write_b128 v14, v[144:147]
    s_waitcnt lgkmcnt(2)
    v_pk_add_f32 v[32:33], v[32:33], v[64:65]
    v_pk_add_f32 v[34:35], v[34:35], v[66:67]
    s_waitcnt lgkmcnt(1)
    v_pk_add_f32 v[36:37], v[36:37], v[68:69]
    v_pk_add_f32 v[38:39], v[38:39], v[70:71]
    v_cvt_pk_bf16_f32 v148, v32, v33
    v_cvt_pk_bf16_f32 v149, v34, v35
    v_cvt_pk_bf16_f32 v150, v36, v37
    v_cvt_pk_bf16_f32 v151, v38, v39
    s_nop 1
    v_permlane32_swap_b32 v148, v150
    v_permlane32_swap_b32 v149, v151
    ds_write_b128 v11, v[148:151]
    s_waitcnt lgkmcnt(0)
    s_barrier
    ds_read_b128 v[128:131], v15
    ds_read_b128 v[132:135], v15 offset:1024
    s_waitcnt lgkmcnt(1)
    buffer_store_dwordx4 v[128:131], v16, s[32:35], 0 offen sc1
    s_waitcnt lgkmcnt(0)
    buffer_store_dwordx4 v[132:135], v16, s[32:35], s60 offen sc1

L_done:
    s_endpgm
L_hc:
    s_xor_b32 s52, s41, 1
    s_lshl_b32 s52, s52, 2
    s_add_u32 s52, s52, s61
    s_lshl_b32 s52, s52, 12
    v_and_b32 v23, 31, v1
    v_lshlrev_b32 v23, 7, v23
    v_add_u32 v23, s52, v23

    s_cmp_lg_u32 s2, 0
    s_cbranch_scc1 L_hc1
    v_lshlrev_b32 v23, 7, v0
L_hc1:
    s_cmp_ge_u32 s45, 8
    s_cbranch_scc1 L_polled_h

    s_sleep 6
    s_mov_b32 s58, 0
L_poll_h:
    buffer_load_dword v24, v23, s[36:39], 0 offen sc1
    s_add_u32 s58, s58, 1
    s_waitcnt vmcnt(0)
    v_cmp_ne_u32 vcc, s40, v24
    s_cbranch_vccz L_polled_h
    s_sleep 2
    s_cmp_lt_u32 s58, 20000
    s_cbranch_scc1 L_poll_h
L_polled_h:

    s_xor_b32 s52, s41, 1
    s_lshl_b32 s52, s52, 20
    s_add_u32 s52, s52, 2097152
    s_add_u32 s24, s18, s52
    s_addc_u32 s25, s19, 0
    s_mov_b32 s26, 1048576
    s_mov_b32 s27, 0x20000

    v_and_b32 v3, 7, v1
    v_lshlrev_b32 v3, 7, v3
    v_bfe_u32 v4, v1, 3, 2
    v_lshl_add_u32 v3, v4, 11, v3
    v_lshrrev_b32 v4, 5, v1
    v_lshl_add_u32 v3, v4, 13, v3
    s_mul_i32 s55, s46, 8
    s_add_u32 s55, s55, s45
    s_barrier
    s_cmp_ge_u32 s45, 8
    s_cbranch_scc1 L_ht_c
L_htl_c:
    s_lshr_b32 s52, s55, 6
    s_xor_b32 s52, s52, s41
    s_xor_b32 s52, s52, 1
    s_lshl_b32 s52, s52, 10
    s_and_b32 s57, s55, 63
    s_lshl_b32 s57, s57, 14
    s_add_u32 s57, s57, s52
    buffer_load_dword v24, v3, s[24:27], s57 offen sc1
    s_add_u32 s55, s55, 64
    s_cmp_lt_u32 s55, 128
    s_cbranch_scc1 L_htl_c
L_ht_c:
    s_barrier

    s_or_b32 s52, s2, s46
    s_cmp_lg_u32 s52, 0
    s_cbranch_scc1 L_hc2
    v_mov_b32 v4, s40
    v_mov_b32 v23, 61440
    buffer_store_dword v4, v23, s[36:39], 0 offen sc1
L_hc2:
    s_waitcnt vmcnt(0)
    s_branch L_g2d

L_l2:
    s_barrier
    s_add_u32 m0, s33, 0
    s_add_u32 s56, s25, 0
    buffer_load_dwordx4 v8, s[20:23], s56 offen lds
    buffer_load_dwordx4 v9, s[20:23], s56 offen offset:1024 lds
    s_add_u32 m0, s34, 0
    s_add_u32 s56, s26, 0
    buffer_load_dwordx4 v8, s[20:23], s56 offen lds
    buffer_load_dwordx4 v9, s[20:23], s56 offen offset:1024 lds
    s_add_u32 m0, s35, 0
    s_add_u32 s56, s27, 0
    buffer_load_dwordx4 v8, s[20:23], s56 offen lds
    buffer_load_dwordx4 v9, s[20:23], s56 offen offset:1024 lds
    s_add_u32 m0, s33, 16384
    s_add_u32 s56, s25, 1409024
    buffer_load_dwordx4 v8, s[20:23], s56 offen lds
    buffer_load_dwordx4 v9, s[20:23], s56 offen offset:1024 lds
    s_add_u32 m0, s34, 16384
    s_add_u32 s56, s26, 1409024
    buffer_load_dwordx4 v8, s[20:23], s56 offen lds
    buffer_load_dwordx4 v9, s[20:23], s56 offen offset:1024 lds
    s_add_u32 m0, s35, 16384
    s_add_u32 s56, s27, 1409024
    buffer_load_dwordx4 v8, s[20:23], s56 offen lds
    buffer_load_dwordx4 v9, s[20:23], s56 offen offset:1024 lds
    s_add_u32 m0, s33, 32768
    s_add_u32 s56, s25, 2818048
    buffer_load_dwordx4 v8, s[20:23], s56 offen lds
    buffer_load_dwordx4 v9, s[20:23], s56 offen offset:1024 lds
    s_add_u32 m0, s34, 32768
    s_add_u32 s56, s26, 2818048
    buffer_load_dwordx4 v8, s[20:23], s56 offen lds
    buffer_load_dwordx4 v9, s[20:23], s56 offen offset:1024 lds
    s_add_u32 m0, s35, 32768
    s_add_u32 s56, s27, 2818048
    buffer_load_dwordx4 v8, s[20:23], s56 offen lds
    buffer_load_dwordx4 v9, s[20:23], s56 offen offset:1024 lds
    s_add_u32 m0, s33, 49152
    s_add_u32 s56, s25, 4227072
    buffer_load_dwordx4 v8, s[20:23], s56 offen lds
    buffer_load_dwordx4 v9, s[20:23], s56 offen offset:1024 lds
    s_add_u32 m0, s34, 49152
    s_add_u32 s56, s26, 4227072
    buffer_load_dwordx4 v8, s[20:23], s56 offen lds
    buffer_load_dwordx4 v9, s[20:23], s56 offen offset:1024 lds
    s_add_u32 m0, s35, 49152
    s_add_u32 s56, s27, 4227072
    buffer_load_dwordx4 v8, s[20:23], s56 offen lds
    buffer_load_dwordx4 v9, s[20:23], s56 offen offset:1024 lds
    s_mov_b32 s58, 0
L_poll_g1:
    buffer_load_dword v24, v23, s[36:39], 0 offen sc1
    s_add_u32 s58, s58, 1
    s_waitcnt vmcnt(0)
    v_cmp_ne_u32 vcc, s40, v24
    s_cbranch_vccz L_polled_g1
    s_sleep 2
    s_cmp_lt_u32 s58, 20000
    s_cbranch_scc1 L_poll_g1
L_polled_g1:

    s_barrier
    s_and_b32 s53, s45, 7
    s_lshr_b32 s52, s44, 1
    s_lshl_b32 s52, s52, 3
    s_add_u32 s47, s52, s53
    s_lshl_b32 s47, s47, 6
    s_mul_i32 s54, s41, 11
    s_mov_b32 s55, s54
    s_lshl_b32 s52, s41, 2
    s_lshr_b32 s48, s45, 3
    s_add_u32 s48, s48, s52
    s_lshl_b32 s48, s48, 6

    s_lshl_b32 s47, s47, 1
    s_mov_b32 s20, s10
    s_mov_b32 s21, s11
    s_mov_b32 s22, 5636096
    s_mov_b32 s23, 0x20000
    v_lshrrev_b32 v4, 3, v1
    v_mul_u32_u24 v3, 4096, v4
    v_bfe_u32 v7, v1, 4, 1
    v_lshlrev_b32 v7, 2, v7
    v_and_b32 v4, 7, v1
    v_xor_b32 v4, v4, v7
    v_lshl_add_u32 v3, v4, 4, v3
    s_mul_i32 s53, s61, 65536
    s_add_u32 s53, s53, s47
    v_add_u32 v8, s53, v3
    v_add_u32 v9, 31744, v8

    v_mov_b32 v12, 81920
    v_mov_b32 v13, 0
    s_barrier
    ds_write_b32 v12, v13
    s_waitcnt lgkmcnt(0)
    s_barrier
    s_add_u32 m0, s51, 4096
    s_lshl_b32 s56, s54, 18
    buffer_load_dwordx4 v8, s[20:23], s56 offen lds
    buffer_load_dwordx4 v9, s[20:23], s56 offen offset:1024 lds
    s_add_u32 s54, s54, 1
    s_cmp_eq_u32 s54, 22
    s_cselect_b32 s54, 0, s54
    s_add_u32 m0, s51, 8192
    s_lshl_b32 s56, s54, 18
    buffer_load_dwordx4 v8, s[20:23], s56 offen lds
    buffer_load_dwordx4 v9, s[20:23], s56 offen offset:1024 lds
    s_add_u32 s54, s54, 1
    s_cmp_eq_u32 s54, 22
    s_cselect_b32 s54, 0, s54
    s_add_u32 m0, s51, 12288
    s_lshl_b32 s56, s54, 18
    buffer_load_dwordx4 v8, s[20:23], s56 offen lds
    buffer_load_dwordx4 v9, s[20:23], s56 offen offset:1024 lds
    s_add_u32 s54, s54, 1
    s_cmp_eq_u32 s54, 22
    s_cselect_b32 s54, 0, s54
    s_barrier
    s_add_u32 m0, s51, 16384
    s_lshl_b32 s56, s54, 18
    buffer_load_dwordx4 v8, s[20:23], s56 offen lds
    buffer_load_dwordx4 v9, s[20:23], s56 offen offset:1024 lds
    s_add_u32 s54, s54, 1
    s_cmp_eq_u32 s54, 22
    s_cselect_b32 s54, 0, s54
    s_add_u32 m0, s51, 20480
    s_lshl_b32 s56, s54, 18
    buffer_load_dwordx4 v8, s[20:23], s56 offen lds
    buffer_load_dwordx4 v9, s[20:23], s56 offen offset:1024 lds
    s_add_u32 s54, s54, 1
    s_cmp_eq_u32 s54, 22
    s_cselect_b32 s54, 0, s54
    s_add_u32 m0, s51, 24576
    s_lshl_b32 s56, s54, 18
    buffer_load_dwordx4 v8, s[20:23], s56 offen lds
    buffer_load_dwordx4 v9, s[20:23], s56 offen offset:1024 lds
    s_add_u32 s54, s54, 1
    s_cmp_eq_u32 s54, 22
    s_cselect_b32 s54, 0, s54
    s_add_u32 m0, s51, 28672
    s_lshl_b32 s56, s54, 18
    buffer_load_dwordx4 v8, s[20:23], s56 offen lds
    buffer_load_dwordx4 v9, s[20:23], s56 offen offset:1024 lds
    s_add_u32 s54, s54, 1
    s_cmp_eq_u32 s54, 22
    s_cselect_b32 s54, 0, s54
    s_barrier
L_g2l:
    s_add_u32 m0, s51, 32768
    s_lshl_b32 s56, s54, 18
    buffer_load_dwordx4 v8, s[20:23], s56 offen lds
    buffer_load_dwordx4 v9, s[20:23], s56 offen offset:1024 lds
    s_add_u32 s54, s54, 1
    s_cmp_eq_u32 s54, 22
    s_cselect_b32 s54, 0, s54
    s_add_u32 m0, s51, 36864
    s_lshl_b32 s56, s54, 18
    buffer_load_dwordx4 v8, s[20:23], s56 offen lds
    buffer_load_dwordx4 v9, s[20:23], s56 offen offset:1024 lds
    s_add_u32 s54, s54, 1
    s_cmp_eq_u32 s54, 22
    s_cselect_b32 s54, 0, s54
    s_add_u32 m0, s51, 40960
    s_lshl_b32 s56, s54, 18
    buffer_load_dwordx4 v8, s[20:23], s56 offen lds
    buffer_load_dwordx4 v9, s[20:23], s56 offen offset:1024 lds
    s_add_u32 s54, s54, 1
    s_cmp_eq_u32 s54, 22
    s_cselect_b32 s54, 0, s54
    s_add_u32 m0, s51, 45056
    s_lshl_b32 s56, s54, 18
    buffer_load_dwordx4 v8, s[20:23], s56 offen lds
    buffer_load_dwordx4 v9, s[20:23], s56 offen offset:1024 lds
    s_add_u32 s54, s54, 1
    s_cmp_eq_u32 s54, 22
    s_cselect_b32 s54, 0, s54
    s_barrier
    s_add_u32 m0, s51, 49152
    s_lshl_b32 s56, s54, 18
    buffer_load_dwordx4 v8, s[20:23], s56 offen lds
    buffer_load_dwordx4 v9, s[20:23], s56 offen offset:1024 lds
    s_add_u32 s54, s54, 1
    s_cmp_eq_u32 s54, 22
    s_cselect_b32 s54, 0, s54
    s_add_u32 m0, s51, 53248
    s_lshl_b32 s56, s54, 18
    buffer_load_dwordx4 v8, s[20:23], s56 offen lds
    buffer_load_dwordx4 v9, s[20:23], s56 offen offset:1024 lds
    s_add_u32 s54, s54, 1
    s_cmp_eq_u32 s54, 22
    s_cselect_b32 s54, 0, s54
    s_add_u32 m0, s51, 57344
    s_lshl_b32 s56, s54, 18
    buffer_load_dwordx4 v8, s[20:23], s56 offen lds
    buffer_load_dwordx4 v9, s[20:23], s56 offen offset:1024 lds
    s_add_u32 s54, s54, 1
    s_cmp_eq_u32 s54, 22
    s_cselect_b32 s54, 0, s54
    s_add_u32 m0, s51, 61440
    s_lshl_b32 s56, s54, 18
    buffer_load_dwordx4 v8, s[20:23], s56 offen lds
    buffer_load_dwordx4 v9, s[20:23], s56 offen offset:1024 lds
    s_add_u32 s54, s54, 1
    s_cmp_eq_u32 s54, 22
    s_cselect_b32 s54, 0, s54
    s_add_u32 m0, s51, 65536
    s_lshl_b32 s56, s54, 18
    buffer_load_dwordx4 v8, s[20:23], s56 offen lds
    buffer_load_dwordx4 v9, s[20:23], s56 offen offset:1024 lds
    s_add_u32 s54, s54, 1
    s_cmp_eq_u32 s54, 22
    s_cselect_b32 s54, 0, s54
    s_add_u32 m0, s51, 69632
    s_lshl_b32 s56, s54, 18
    buffer_load_dwordx4 v8, s[20:23], s56 offen lds
    buffer_load_dwordx4 v9, s[20:23], s56 offen offset:1024 lds
    s_add_u32 s54, s54, 1
    s_cmp_eq_u32 s54, 22
    s_cselect_b32 s54, 0, s54
    s_add_u32 m0, s51, 73728
    s_lshl_b32 s56, s54, 18
    buffer_load_dwordx4 v8, s[20:23], s56 offen lds
    buffer_load_dwordx4 v9, s[20:23], s56 offen offset:1024 lds
    s_add_u32 s54, s54, 1
    s_cmp_eq_u32 s54, 22
    s_cselect_b32 s54, 0, s54
    s_add_u32 m0, s51, 77824
    s_lshl_b32 s56, s54, 18
    buffer_load_dwordx4 v8, s[20:23], s56 offen lds
    buffer_load_dwordx4 v9, s[20:23], s56 offen offset:1024 lds
    s_add_u32 s54, s54, 1
    s_cmp_eq_u32 s54, 22
    s_cselect_b32 s54, 0, s54
    s_add_u32 m0, s51, 0
    s_lshl_b32 s56, s54, 18
    buffer_load_dwordx4 v8, s[20:23], s56 offen lds
    buffer_load_dwordx4 v9, s[20:23], s56 offen offset:1024 lds
    s_add_u32 s54, s54, 1
    s_cmp_eq_u32 s54, 22
    s_cselect_b32 s54, 0, s54
    v_min_u32 v23, 21, v1
    s_lshr_b32 s52, s48, 6
    s_mul_i32 s52, s52, 22
    s_add_u32 s52, s52, 256
    v_add_u32 v23, s52, v23
    v_lshlrev_b32 v23, 7, v23
    s_cmp_lg_u32 s46, 4
    s_cbranch_scc1 L_polled_g2

    s_mov_b32 s58, 0
L_poll_g2:
    buffer_load_dword v24, v23, s[36:39], 0 offen sc1
    s_add_u32 s58, s58, 1
    s_waitcnt vmcnt(0)
    v_cmp_ne_u32 vcc, s40, v24
    s_cbranch_vccz L_polled_g2
    s_sleep 2
    s_cmp_lt_u32 s58, 20000
    s_cbranch_scc1 L_poll_g2
L_polled_g2:

    s_waitcnt vmcnt(0)
    s_barrier
    s_barrier
    s_add_u32 m0, s51, 4096
    s_lshl_b32 s56, s54, 18
    buffer_load_dwordx4 v8, s[20:23], s56 offen lds
    buffer_load_dwordx4 v9, s[20:23], s56 offen offset:1024 lds
    s_add_u32 s54, s54, 1
    s_cmp_eq_u32 s54, 22
    s_cselect_b32 s54, 0, s54
    s_add_u32 m0, s51, 8192
    s_lshl_b32 s56, s54, 18
    buffer_load_dwordx4 v8, s[20:23], s56 offen lds
    buffer_load_dwordx4 v9, s[20:23], s56 offen offset:1024 lds
    s_add_u32 s54, s54, 1
    s_cmp_eq_u32 s54, 22
    s_cselect_b32 s54, 0, s54
    s_waitcnt vmcnt(0)
    s_barrier
    s_endpgm
L_agent2:
    s_mov_b32 s36, s18
    s_mov_b32 s37, s19
    s_mov_b32 s38, 65536
    s_mov_b32 s39, 0x20000
    s_and_b32 s53, s45, 7
    s_lshr_b32 s52, s44, 1
    s_lshl_b32 s52, s52, 3
    s_add_u32 s47, s52, s53
    s_lshl_b32 s47, s47, 6
    s_mul_i32 s54, s41, 11
    s_mov_b32 s55, s54
    s_lshl_b32 s52, s41, 2
    s_lshr_b32 s48, s45, 3
    s_add_u32 s48, s48, s52
    s_lshl_b32 s48, s48, 6

    s_lshl_b32 s47, s47, 1
    s_mov_b32 s20, s10
    s_mov_b32 s21, s11
    s_mov_b32 s22, 5636096
    s_mov_b32 s23, 0x20000
    v_lshrrev_b32 v4, 3, v1
    v_mul_u32_u24 v3, 4096, v4
    v_bfe_u32 v7, v1, 4, 1
    v_lshlrev_b32 v7, 2, v7
    v_and_b32 v4, 7, v1
    v_xor_b32 v4, v4, v7
    v_lshl_add_u32 v3, v4, 4, v3
    s_mul_i32 s53, s61, 65536
    s_add_u32 s53, s53, s47
    v_add_u32 v8, s53, v3
    v_add_u32 v9, 31744, v8

    s_barrier
    s_add_u32 m0, s51, 4096
    s_lshl_b32 s56, s54, 18
    buffer_load_dwordx4 v8, s[20:23], s56 offen lds
    buffer_load_dwordx4 v9, s[20:23], s56 offen offset:1024 lds
    s_add_u32 s54, s54, 1
    s_cmp_eq_u32 s54, 22
    s_cselect_b32 s54, 0, s54
    s_add_u32 m0, s51, 8192
    s_lshl_b32 s56, s54, 18
    buffer_load_dwordx4 v8, s[20:23], s56 offen lds
    buffer_load_dwordx4 v9, s[20:23], s56 offen offset:1024 lds
    s_add_u32 s54, s54, 1
    s_cmp_eq_u32 s54, 22
    s_cselect_b32 s54, 0, s54
    s_add_u32 m0, s51, 12288
    s_lshl_b32 s56, s54, 18
    buffer_load_dwordx4 v8, s[20:23], s56 offen lds
    buffer_load_dwordx4 v9, s[20:23], s56 offen offset:1024 lds
    s_add_u32 s54, s54, 1
    s_cmp_eq_u32 s54, 22
    s_cselect_b32 s54, 0, s54
    s_add_u32 m0, s51, 16384
    s_lshl_b32 s56, s54, 18
    buffer_load_dwordx4 v8, s[20:23], s56 offen lds
    buffer_load_dwordx4 v9, s[20:23], s56 offen offset:1024 lds
    s_add_u32 s54, s54, 1
    s_cmp_eq_u32 s54, 22
    s_cselect_b32 s54, 0, s54
    s_xor_b32 s52, s41, 1
    s_lshl_b32 s52, s52, 20
    s_add_u32 s52, s52, 2097152
    s_add_u32 s24, s18, s52
    s_addc_u32 s25, s19, 0
    s_mov_b32 s26, 1048576
    s_mov_b32 s27, 0x20000

    v_and_b32 v3, 7, v1
    v_lshlrev_b32 v3, 7, v3
    v_bfe_u32 v4, v1, 3, 2
    v_lshl_add_u32 v3, v4, 11, v3
    v_lshrrev_b32 v4, 5, v1
    v_lshl_add_u32 v3, v4, 13, v3
    s_mul_i32 s55, s46, 8
    s_add_u32 s55, s55, s45
    s_barrier
    s_cmp_ge_u32 s45, 8
    s_cbranch_scc1 L_ht_a
L_htl_a:
    s_lshr_b32 s52, s55, 6
    s_xor_b32 s52, s52, s41
    s_xor_b32 s52, s52, 1
    s_lshl_b32 s52, s52, 10
    s_and_b32 s57, s55, 63
    s_lshl_b32 s57, s57, 14
    s_add_u32 s57, s57, s52
    buffer_load_dword v24, v3, s[24:27], s57 offen sc1
    s_add_u32 s55, s55, 64
    s_cmp_lt_u32 s55, 128
    s_cbranch_scc1 L_htl_a
L_ht_a:
    s_barrier

    s_add_u32 m0, s51, 20480
    s_lshl_b32 s56, s54, 18
    buffer_load_dwordx4 v8, s[20:23], s56 offen lds
    buffer_load_dwordx4 v9, s[20:23], s56 offen offset:1024 lds
    s_add_u32 s54, s54, 1
    s_cmp_eq_u32 s54, 22
    s_cselect_b32 s54, 0, s54
    s_add_u32 m0, s51, 24576
    s_lshl_b32 s56, s54, 18
    buffer_load_dwordx4 v8, s[20:23], s56 offen lds
    buffer_load_dwordx4 v9, s[20:23], s56 offen offset:1024 lds
    s_add_u32 s54, s54, 1
    s_cmp_eq_u32 s54, 22
    s_cselect_b32 s54, 0, s54
    s_add_u32 m0, s51, 28672
    s_lshl_b32 s56, s54, 18
    buffer_load_dwordx4 v8, s[20:23], s56 offen lds
    buffer_load_dwordx4 v9, s[20:23], s56 offen offset:1024 lds
    s_add_u32 s54, s54, 1
    s_cmp_eq_u32 s54, 22
    s_cselect_b32 s54, 0, s54
    s_branch L_g2l
L_end:
.section .rodata,"a"
.p2align 6
.amdhsa_kernel standalone__mixer_token_mlp__prompt_kernel
  .amdhsa_next_free_vgpr 184
  .amdhsa_next_free_sgpr 100
  .amdhsa_accum_offset 184
  .amdhsa_group_segment_fixed_size 0
  .amdhsa_kernarg_size 64
  .amdhsa_user_sgpr_count 2
  .amdhsa_user_sgpr_kernarg_segment_ptr 1
  .amdhsa_system_sgpr_workgroup_id_x 1
  .amdhsa_float_denorm_mode_32 3
  .amdhsa_float_denorm_mode_16_64 3
.end_amdhsa_kernel
```
